```python
import torch

def _softmax(x, axis=-1):
    return torch.softmax(x, dim=axis)
def _gelu(x):
    return torch.nn.functional.gelu(x, approximate="tanh")
def _silu(x):
    return torch.nn.functional.silu(x)
def _sigmoid(x):
    return torch.sigmoid(x)
def _layernorm(x, axis=-1, eps=1e-5):
    m = x.mean(dim=axis, keepdim=True)
    v = x.var(dim=axis, keepdim=True, unbiased=False)
    return (x - m) / torch.sqrt(v + eps)
def _scatter_add(tgt, idx, src, axis=0):
    return tgt.clone().index_add_(axis, idx, src)
def _segment_sum(src, seg, n):
    out = torch.zeros((n,) + src.shape[1:], dtype=src.dtype)
    return out.index_add_(0, seg, src)
def _pad(x, pw):
    flat = tuple(v for pair in reversed(pw) for v in pair)
    return torch.nn.functional.pad(x, flat)

kernel_name = 'sequential_preLN__grouped_kv_mqa__dense_activation_gelu__prompt'

def setup_inputs():

    _w = (lambda a: (lambda t: t.to(torch.bfloat16) if t.is_floating_point() else t)(torch.as_tensor(a)))
    def _A_setup():
        B, S, D, H = 1, 2048, 512, 32
        Dh = D // H
        return {
            "x": _w((lambda *s: torch.randn(*s, dtype=torch.bfloat16) * 0.05)(B, S, D)),
            "wq": _w((lambda *s: torch.randn(*s, dtype=torch.bfloat16) * 0.05)(D, H * Dh)),
            "wk": _w((lambda *s: torch.randn(*s, dtype=torch.bfloat16) * 0.05)(D, Dh)),
            "wv": _w((lambda *s: torch.randn(*s, dtype=torch.bfloat16) * 0.05)(D, Dh)),
            "wo": _w((lambda *s: torch.randn(*s, dtype=torch.bfloat16) * 0.05)(H * Dh, D)),
        }
    _A_in = _A_setup()

    def _B_setup():
        B, S, D, F = 1, 2048, 512, 1376
        return {
            "x": _w((lambda *s: torch.randn(*s, dtype=torch.bfloat16) * 0.05)(B, S, D)),
            "w1": _w((lambda *s: torch.randn(*s, dtype=torch.bfloat16) * 0.8)(D, F) * (D ** -0.5)),
            "b1": _w((lambda *s: torch.randn(*s, dtype=torch.bfloat16) * 0.8)(F) * 0.01),
            "w2": _w((lambda *s: torch.randn(*s, dtype=torch.bfloat16) * 0.2)(F, D) * (F ** -0.5)),
            "b2": _w((lambda *s: torch.randn(*s, dtype=torch.bfloat16) * 0.2)(D) * 0.01),
        }
    _B_in = _B_setup()

    return {
        "A_x": _A_in["x"],
        "A_wq": _A_in["wq"],
        "A_wk": _A_in["wk"],
        "A_wv": _A_in["wv"],
        "A_wo": _A_in["wo"],
        "B_x": _B_in["x"],
        "B_w1": _B_in["w1"],
        "B_b1": _B_in["b1"],
        "B_w2": _B_in["w2"],
        "B_b2": _B_in["b2"],
    }

def reference(A_x, A_wq, A_wk, A_wv, A_wo, B_x, B_w1, B_b1, B_w2, B_b2):
    def _A_ref(x, wq, wk, wv, wo):
        B, S, D = x.shape
        H = 32
        Dh = D // H
        q = (lambda x, *d: x.permute(*d))((x @ wq).reshape(B, S, H, Dh), 0, 2, 1, 3)
        k = x @ wk
        v = x @ wv
        scores = torch.einsum("bhqd,bkd->bhqk", q, k) * (Dh ** -0.5)
        p = _softmax(scores, axis=-1)
        o = torch.einsum("bhqk,bkd->bhqd", p, v)
        return (lambda x, *d: x.permute(*d))(o, 0, 2, 1, 3).reshape(B, S, H * Dh) @ wo

    def _B_ref(x, w1, b1, w2, b2):
        h = torch.einsum("bsd,df->bsf", x, w1) + b1
        h = _gelu(h)
        return torch.einsum("bsf,fd->bsd", h, w2) + b2

    x = A_x
    h = x + _A_ref(_layernorm(x, axis=-1), A_wq, A_wk, A_wv, A_wo)
    h2 = h + _B_ref(_layernorm(h, axis=-1), B_w1, B_b1, B_w2, B_b2)
    return h2
```

```asm
; @launch grid=(256,1,1) block=(512,1,1) lds=163840
.amdgcn_target "amdgcn-amd-amdhsa--gfx950"
.text
.globl sequential_preLN__grouped_kv_mqa__dense_activation_gelu__prompt_kernel
.p2align 8
.type sequential_preLN__grouped_kv_mqa__dense_activation_gelu__prompt_kernel,@function
sequential_preLN__grouped_kv_mqa__dense_activation_gelu__prompt_kernel:
    s_cmp_ge_u32 s2, 256
    s_cbranch_scc1 L_k2_end
    s_load_dwordx16 s[16:31], s[0:1], 0
    s_load_dwordx8 s[32:39], s[0:1], 64
    s_load_dwordx2 s[40:41], s[0:1], 96
    s_getpc_b64 s[12:13]
    s_bfe_u32 s14, s2, 0x30003
    s_lshl_b32 s14, s14, 13
    v_lshlrev_b32 v2, 7, v0
    v_subrev_u32 v2, 0xe000, v2
    v_add_u32 v2, s14, v2
    v_cmp_le_u32 vcc, 448, v0
    s_cmp_lt_u32 s14, 0x8000
    s_cselect_b64 s[14:15], vcc, 0
    s_cmp_eq_u64 s[14:15], 0
    s_cbranch_scc1 L_cpf
    global_load_dword v123, v2, s[12:13]
L_cpf:
    v_lshrrev_b32 v2, 6, v0
    v_and_b32 v1, 63, v0
    s_and_b32 s4, s2, 7
    s_lshl_b32 s4, s4, 2
    s_lshr_b32 s5, s2, 6
    v_readfirstlane_b32 s3, v2
    s_add_u32 s4, s4, s5
    s_bfe_u32 s5, s2, 0x30003
    v_lshrrev_b32 v4, 3, v1
    v_and_b32 v5, 7, v1
    v_lshrrev_b32 v10, 1, v4
    v_xor_b32 v10, v10, v5
    v_lshlrev_b32 v10, 4, v10
    v_lshl_or_b32 v6, v4, 10, v10
    v_xor_b32 v7, 64, v6
    v_bfe_u32 v10, v4, 1, 1
    v_lshlrev_b32 v10, 2, v10
    v_xor_b32 v10, v10, v5
    v_lshlrev_b32 v10, 4, v10
    v_lshl_or_b32 v8, v4, 10, v10
    v_lshlrev_b32 v3, 4, v1
    v_lshlrev_b32 v111, 5, v1
    s_and_b32 s96, s5, 6
    s_lshl_b32 s7, s4, 16
    s_lshl_b32 s8, s3, 7
    s_add_u32 s7, s7, s8
    s_lshl_b32 s8, s3, 13
    s_lshl_b32 s66, s3, 12
    s_add_u32 s66, s66, 131072
    s_lshl_b32 s9, s5, 7
    s_lshr_b32 s6, s2, 6
    s_lshl_b32 s6, s6, 4
    s_add_u32 s6, s6, s3
    s_add_u32 s6, s6, 63
    s_lshl_b32 s10, s3, 10
    s_lshl_b32 s11, s3, 11
    s_lshl_b32 s68, s4, 10
    s_add_u32 s68, s68, 0x230000
    s_getreg_b32 s42, hwreg(HW_REG_XCC_ID)
    s_and_b32 s42, s42, 15
    s_add_u32 s42, s42, 1
    s_mov_b32 m0, s66
    s_mov_b32 s90, 16384
    s_mov_b32 s91, 0x00020000
    s_mov_b32 s78, 2097152
    s_mov_b32 s79, 0x00020000
    s_bitcmp1_b32 s5, 0
    s_cbranch_scc1 L_p_wv
    s_waitcnt lgkmcnt(0)
    s_mov_b32 s88, s20
    s_and_b32 s89, s21, 0xffff
    s_branch L_p_w
L_p_wv:
    s_waitcnt lgkmcnt(0)
    s_mov_b32 s88, s22
    s_and_b32 s89, s23, 0xffff
L_p_w:
    buffer_load_dwordx4 v3, s[88:91], s11 offen lds
    buffer_load_dwordx4 v3, s[88:91], s11 offen offset:1024 lds
    s_mov_b32 s76, s16
    s_and_b32 s77, s17, 0xffff
    s_xor_b32 s13, s96, 0
    s_lshl_b32 s14, s13, 10
    s_add_u32 m0, s8, s14
    s_lshl_b32 s13, s13, 13
    s_add_u32 s13, s13, s7
    buffer_load_dwordx4 v6, s[76:79], s13 offen lds
    s_xor_b32 s13, s96, 1
    s_lshl_b32 s14, s13, 10
    s_add_u32 m0, s8, s14
    s_lshl_b32 s13, s13, 13
    s_add_u32 s13, s13, s7
    buffer_load_dwordx4 v7, s[76:79], s13 offen lds
    s_mov_b32 s52, s40
    s_and_b32 s53, s41, 0xffff
    s_mov_b32 s54, 0x1000000
    s_mov_b32 s55, 0x00020000
    s_mov_b32 s84, s18
    s_and_b32 s85, s19, 0xffff
    s_mov_b32 s86, 0x80000
    s_mov_b32 s87, 0x00020000
    s_barrier
    s_cmp_eq_u32 s3, 0
    s_cbranch_scc1 L_p_m0
    s_cmp_lt_u32 s3, 4
    s_cbranch_scc1 L_p_m1
    s_sub_u32 s82, s3, 4
    s_lshl_b32 s82, s82, 11
    s_add_u32 s82, s82, 0x240000
    buffer_load_dword v108, v111, s[52:55], s82 offen sc1
L_p_m1:
    s_add_u32 s13, s6, 0
    s_and_b32 s13, s13, 63
    s_lshl_b32 s14, s13, 10
    s_add_u32 m0, s14, 65536
    s_lshl_b32 s13, s13, 13
    s_add_u32 s13, s13, s9
    buffer_load_dwordx4 v8, s[84:87], s13 offen lds
    s_branch L_p_md
L_p_m0:
    s_lshl_b32 s82, s2, 5
    s_add_u32 s82, s82, 0x240000
    s_mov_b64 exec, 1
    buffer_load_dword v108, v3, s[52:55], s82 offen sc1
    s_mov_b64 exec, -1
    s_setprio 3
    s_xor_b32 s13, s96, 5
    s_lshl_b32 s14, s13, 10
    s_add_u32 m0, s8, s14
    s_lshl_b32 s13, s13, 13
    s_add_u32 s13, s13, s7
    buffer_load_dwordx4 v7, s[76:79], s13 offen lds
L_p_md:
    v_and_b32 v12, 15, v1
    v_lshrrev_b32 v13, 4, v1
    s_lshl_b32 s13, s96, 3
    v_add_u32 v14, s13, v12
    v_bfe_u32 v15, v14, 1, 3
    v_xor_b32 v15, v15, v13
    v_lshlrev_b32 v14, 7, v14
    v_lshl_or_b32 v14, v15, 4, v14
    v_add_u32 v14, s8, v14
    v_xor_b32 v15, 64, v14
    v_lshlrev_b32 v16, 3, v12
    v_lshl_or_b32 v16, v13, 8, v16
    v_add_u32 v16, s66, v16
    v_add_u32 v17, s66, v3
    v_mov_b64 v[148:149], 0
    v_mov_b64 v[150:151], 0
    s_mov_b32 s83, 0x3f803f80
    v_lshlrev_b32 v18, 4, v13
    v_mov_b32 v109, 0
    s_lshl_b32 s13, s4, 1
    s_lshr_b32 s14, s5, 2
    s_add_u32 s13, s13, s14
    s_lshl_b32 s13, s13, 11
    s_add_u32 s97, s13, 0x200000
    s_bfe_u32 s14, s5, 0x10001
    s_lshl_b32 s14, s14, 8
    s_bitcmp1_b32 s5, 0
    s_cbranch_scc1 L_p_av
    s_add_u32 s97, s97, s14
    v_lshrrev_b32 v19, 1, v13
    v_lshlrev_b32 v19, 9, v19
    v_lshl_or_b32 v19, v12, 4, v19
    v_and_b32 v10, 1, v13
    v_lshl_or_b32 v19, v10, 3, v19
    s_branch L_p_ad
L_p_av:
    v_and_b32 v19, 0x13, v12
    v_and_b32 v10, 4, v12
    v_lshl_or_b32 v19, v10, 1, v19
    v_and_b32 v10, 8, v12
    v_lshrrev_b32 v10, 1, v10
    v_or_b32 v19, v19, v10
    s_xor_b32 s14, s14, 256
    s_add_u32 s97, s97, s14
    s_add_u32 s97, s97, 1024
    v_lshlrev_b32 v19, 4, v19
    v_and_b32 v10, 1, v13
    v_lshl_or_b32 v19, v10, 3, v19
    v_lshrrev_b32 v10, 1, v13
    v_lshl_or_b32 v19, v10, 9, v19
L_p_ad:
    s_mov_b32 s44, s28
    s_and_b32 s45, s29, 0xffff
    s_mov_b32 s46, 0x158000
    s_mov_b32 s47, 0x00020000
    s_lshr_b32 s13, s3, 1
    s_add_u32 s13, s13, 2
    s_min_u32 s43, s13, s3
    s_mul_i32 s14, s5, 6
    s_mul_i32 s15, s5, 5
    s_add_u32 s15, s15, 3
    s_min_u32 s14, s14, s15
    s_add_u32 s65, s14, s43
    s_lshl_b32 s67, s65, 6
    s_cmp_eq_u32 s43, 5
    s_cselect_b32 s13, s5, 0
    s_cmp_ge_u32 s13, 3
    s_cselect_b32 s67, 0x400000, s67
    v_lshrrev_b32 v125, 2, v1
    s_movk_i32 s13, 2752
    v_mul_u32_u24 v125, s13, v125
    v_and_b32 v127, 3, v1
    v_lshl_add_u32 v125, v127, 4, v125
    v_lshrrev_b32 v127, 5, v1
    v_lshlrev_b32 v124, 9, v127
    v_bfe_u32 v127, v1, 2, 2
    v_lshl_or_b32 v124, v127, 6, v124
    v_bfe_u32 v127, v1, 4, 1
    v_lshl_or_b32 v124, v127, 5, v124
    v_and_b32 v127, 1, v1
    v_lshl_or_b32 v124, v127, 4, v124
    v_bfe_u32 v127, v1, 1, 1
    v_lshl_or_b32 v124, v127, 3, v124
    v_add_u32 v124, s66, v124
    v_lshrrev_b32 v127, 2, v1
    v_lshlrev_b32 v126, 10, v127
    v_and_b32 v127, 3, v1
    v_lshl_or_b32 v126, v127, 4, v126
    v_and_b32 v127, 32, v1
    v_xor_b32 v126, v127, v126
    s_mov_b32 s60, 0xffff0000
    s_mov_b32 s61, 0xffff0000
    s_and_b32 s70, s3, 1
    s_bfe_u32 s71, s3, 0x10001
    s_lshr_b32 s72, s3, 2
    s_lshl_b32 s12, s72, 16
    v_add_u32 v2, s12, v3
    v_and_b32 v40, 27, v1
    v_cmp_eq_u32 vcc, 0, v40
    v_mov_b32 v41, 0x3f803f80
    s_nop 0
    v_cndmask_b32 v20, 0, v41, vcc
    v_mov_b32 v21, v20
    v_mov_b64 v[22:23], v[20:21]
    v_mov_b64 v[24:25], v[20:21]
    v_mov_b64 v[26:27], v[20:21]
    v_mov_b64 v[28:29], v[20:21]
    v_mov_b64 v[30:31], v[20:21]
    v_mov_b64 v[32:33], v[20:21]
    v_mov_b64 v[34:35], v[20:21]
    v_mov_b64 v[60:61], 0
    v_mov_b64 v[62:63], 0
    v_mov_b64 v[64:65], 0
    v_mov_b64 v[66:67], 0
    v_mov_b64 v[68:69], 0
    v_mov_b64 v[70:71], 0
    v_mov_b64 v[72:73], 0
    v_mov_b64 v[74:75], 0
    v_mov_b64 v[76:77], 0
    v_mov_b64 v[78:79], 0
    v_mov_b64 v[80:81], 0
    v_mov_b64 v[82:83], 0
    v_mov_b64 v[84:85], 0
    v_mov_b64 v[86:87], 0
    v_mov_b64 v[88:89], 0
    v_mov_b64 v[90:91], 0
    v_mov_b32 v43, 0xdddddddd
    s_xor_b32 s12, s66, s10
    v_xor_b32 v41, s12, v124
    v_add_u32 v42, 0x10000, v41
    v_and_b32 v4, 31, v1
    v_lshrrev_b32 v5, 5, v1
    v_bfe_u32 v11, v4, 1, 3
    v_xor_b32 v11, v11, v5
    s_mul_i32 s12, s72, 4160
    s_lshl_b32 s15, s70, 15
    s_add_u32 s12, s12, s15
    v_lshlrev_b32 v11, 4, v11
    v_lshl_or_b32 v11, v4, 7, v11
    v_xor_b32 v112, s12, v11
    v_xor_b32 v113, 32, v112
    v_xor_b32 v114, 64, v112
    v_xor_b32 v115, 96, v112
    v_bfe_u32 v10, v1, 4, 1
    v_and_b32 v11, 1, v1
    v_lshl_or_b32 v10, v10, 1, v11
    v_bfe_u32 v11, v1, 3, 1
    v_lshl_or_b32 v10, v11, 2, v10
    v_lshlrev_b32 v10, 4, v10
    v_bfe_u32 v11, v1, 1, 1
    v_lshl_or_b32 v10, v11, 3, v10
    v_bfe_u32 v11, v1, 2, 2
    v_lshl_or_b32 v10, v11, 7, v10
    v_lshl_or_b32 v10, v5, 10, v10
    s_lshl_b32 s13, s70, 5
    s_add_u32 s15, s15, s13
    s_lshl_b32 s13, s71, 6
    s_add_u32 s15, s15, s13
    s_lshl_b32 s13, s72, 12
    s_add_u32 s15, s15, s13
    s_add_u32 s15, s15, 65536
    v_xor_b32 v116, s15, v10
    v_xor_b32 v117, 2048, v116
    v_xor_b32 v118, 4096, v116
    v_xor_b32 v119, 6144, v116
    s_lshl_b32 s13, s72, 8
    s_add_u32 s13, s13, 131072
    v_lshl_add_u32 v104, v4, 3, s13
    v_lshl_add_u32 v106, v1, 2, s66
    s_lshl_b32 s13, s71, 13
    s_lshl_b32 s14, s70, 6
    s_add_u32 s13, s13, s14
    s_add_u32 s13, s13, 131072
    v_lshl_add_u32 v105, v5, 4, s13
    v_xor_b32 v107, 64, v105
    v_xor_b32 v110, 0x4000, v17
    v_xor_b32 v103, 0x1000, v17
    v_xor_b32 v102, 0x4000, v106
    v_lshl_add_u32 v101, v1, 3, s66
    v_bfe_u32 v9, v1, 1, 3
    v_lshlrev_b32 v9, 4, v9
    v_lshl_or_b32 v9, v1, 7, v9
    v_add_u32 v9, s8, v9
    s_lshl_b32 s13, s3, 4
    s_add_u32 s13, s13, 131648
    v_lshl_add_u32 v100, v13, 2, s13
    s_mov_b32 s13, 131712
    v_lshl_add_u32 v95, v12, 2, s13
    v_cmp_eq_u32 vcc, 0, v4
    v_cmp_eq_u32 s[12:13], 17, v4
    s_or_b64 vcc, vcc, s[12:13]
    v_mov_b32 v10, s83
    v_mov_b64 v[96:97], 0
    v_cndmask_b32 v120, 0, v10, vcc
    v_mov_b32 v121, v120
    v_mov_b32 v122, v120
    v_mov_b64 v[98:99], 0
    v_mov_b32 v36, 0
    s_cmp_eq_u32 s3, 0
    s_cbranch_scc1 L_p_r0
    s_add_u32 s13, s6, 7
    s_and_b32 s13, s13, 63
    s_lshl_b32 s14, s13, 10
    s_add_u32 m0, s14, 65536
    s_lshl_b32 s13, s13, 13
    s_add_u32 s13, s13, s9
    buffer_load_dwordx4 v8, s[84:87], s13 offen lds
    s_add_u32 s13, s6, 14
    s_and_b32 s13, s13, 63
    s_lshl_b32 s14, s13, 10
    s_add_u32 m0, s14, 65536
    s_lshl_b32 s13, s13, 13
    s_add_u32 s13, s13, s9
    buffer_load_dwordx4 v8, s[84:87], s13 offen lds
    s_branch L_p_r1
L_p_r0:
    s_xor_b32 s13, s96, 6
    s_lshl_b32 s14, s13, 10
    s_add_u32 m0, s8, s14
    s_lshl_b32 s13, s13, 13
    s_add_u32 s13, s13, s7
    buffer_load_dwordx4 v6, s[76:79], s13 offen lds
    s_xor_b32 s13, s96, 7
    s_lshl_b32 s14, s13, 10
    s_add_u32 m0, s8, s14
    s_lshl_b32 s13, s13, 13
    s_add_u32 s13, s13, s7
    buffer_load_dwordx4 v7, s[76:79], s13 offen lds
L_p_r1:
    s_sub_u32 s13, s3, 1
    s_cmp_lt_u32 s13, 3
    s_cbranch_scc0 L_p_w3
    s_waitcnt vmcnt(3)
L_p_w3:
    s_waitcnt vmcnt(4)
    ds_read_b64_tr_b16 v[128:129], v16 offset:0
    ds_read_b64_tr_b16 v[130:131], v16 offset:128
    ds_read_b64_tr_b16 v[132:133], v16 offset:1024
    ds_read_b64_tr_b16 v[134:135], v16 offset:1152
    ds_read_b128 v[136:139], v14
    ds_read_b128 v[140:143], v15
    s_xor_b32 s13, s96, 2
    s_lshl_b32 s14, s13, 10
    s_add_u32 m0, s8, s14
    s_lshl_b32 s13, s13, 13
    s_add_u32 s13, s13, s7
    buffer_load_dwordx4 v6, s[76:79], s13 offen lds
    s_xor_b32 s13, s96, 3
    s_lshl_b32 s14, s13, 10
    s_add_u32 m0, s8, s14
    s_lshl_b32 s13, s13, 13
    s_add_u32 s13, s13, s7
    buffer_load_dwordx4 v7, s[76:79], s13 offen lds
    s_xor_b32 s13, s96, 4
    s_lshl_b32 s14, s13, 10
    s_add_u32 m0, s8, s14
    s_lshl_b32 s13, s13, 13
    s_add_u32 s13, s13, s7
    buffer_load_dwordx4 v6, s[76:79], s13 offen lds
    v_mov_b32 v123, v120
    s_waitcnt lgkmcnt(0)
    s_bitcmp1_b32 s5, 0
    s_cbranch_scc1 L_p_mv
    v_mfma_f32_16x16x32_bf16 v[144:147], v[128:131], v[136:139], 0
    v_mfma_f32_16x16x32_bf16 v[144:147], v[132:135], v[140:143], v[144:147]
    s_branch L_p_mk
L_p_mv:
    v_mfma_f32_16x16x32_bf16 v[144:147], v[136:139], v[128:131], 0
    v_mfma_f32_16x16x32_bf16 v[144:147], v[140:143], v[132:135], v[144:147]
L_p_mk:
    v_dot2c_f32_bf16 v148, s83, v136
    v_dot2c_f32_bf16 v149, v136, v136
    v_dot2c_f32_bf16 v150, s83, v128
    v_dot2c_f32_bf16 v148, s83, v137
    v_dot2c_f32_bf16 v149, v137, v137
    v_dot2c_f32_bf16 v150, s83, v129
    v_dot2c_f32_bf16 v148, s83, v138
    v_dot2c_f32_bf16 v149, v138, v138
    v_dot2c_f32_bf16 v150, s83, v130
    v_dot2c_f32_bf16 v148, s83, v139
    v_dot2c_f32_bf16 v149, v139, v139
    v_dot2c_f32_bf16 v150, s83, v131
    v_dot2c_f32_bf16 v148, s83, v140
    v_dot2c_f32_bf16 v149, v140, v140
    v_dot2c_f32_bf16 v150, s83, v132
    v_dot2c_f32_bf16 v148, s83, v141
    v_dot2c_f32_bf16 v149, v141, v141
    v_dot2c_f32_bf16 v150, s83, v133
    v_dot2c_f32_bf16 v148, s83, v142
    v_dot2c_f32_bf16 v149, v142, v142
    v_dot2c_f32_bf16 v150, s83, v134
    v_dot2c_f32_bf16 v148, s83, v143
    v_dot2c_f32_bf16 v149, v143, v143
    v_dot2c_f32_bf16 v150, s83, v135
    ds_write_b128 v17, v[144:147] offset:2048
    s_nop 1
    ds_write_b128 v17, v[148:151] offset:3072
    s_waitcnt vmcnt(6) lgkmcnt(0)
    s_barrier
    s_cmp_eq_u32 s3, 0
    s_cbranch_scc1 L_p_fin
    s_xor_b32 s13, s96, 5
    s_lshl_b32 s14, s13, 10
    s_add_u32 m0, s8, s14
    s_lshl_b32 s13, s13, 13
    s_add_u32 s13, s13, s7
    buffer_load_dwordx4 v7, s[76:79], s13 offen lds
    s_xor_b32 s13, s96, 6
    s_lshl_b32 s14, s13, 10
    s_add_u32 m0, s8, s14
    s_lshl_b32 s13, s13, 13
    s_add_u32 s13, s13, s7
    buffer_load_dwordx4 v6, s[76:79], s13 offen lds
    s_xor_b32 s13, s96, 7
    s_lshl_b32 s14, s13, 10
    s_add_u32 m0, s8, s14
    s_lshl_b32 s13, s13, 13
    s_add_u32 s13, s13, s7
    buffer_load_dwordx4 v7, s[76:79], s13 offen lds
    s_add_u32 s13, s6, 21
    s_and_b32 s13, s13, 63
    s_lshl_b32 s14, s13, 10
    s_add_u32 m0, s14, 65536
    s_lshl_b32 s13, s13, 13
    s_add_u32 s13, s13, s9
    buffer_load_dwordx4 v8, s[84:87], s13 offen lds
    s_add_u32 s13, s6, 28
    s_and_b32 s13, s13, 63
    s_lshl_b32 s14, s13, 10
    s_add_u32 m0, s14, 65536
    s_lshl_b32 s13, s13, 13
    s_add_u32 s13, s13, s9
    buffer_load_dwordx4 v8, s[84:87], s13 offen lds
    s_waitcnt vmcnt(11)
    s_barrier
    s_add_u32 s13, s6, 35
    s_and_b32 s13, s13, 63
    s_lshl_b32 s14, s13, 10
    s_add_u32 m0, s14, 65536
    s_lshl_b32 s13, s13, 13
    s_add_u32 s13, s13, s9
    buffer_load_dwordx4 v8, s[84:87], s13 offen lds
    s_add_u32 s13, s6, 42
    s_and_b32 s13, s13, 63
    s_lshl_b32 s14, s13, 10
    s_add_u32 m0, s14, 65536
    s_lshl_b32 s13, s13, 13
    s_add_u32 s13, s13, s9
    buffer_load_dwordx4 v8, s[84:87], s13 offen lds
    s_add_u32 s13, s6, 49
    s_and_b32 s13, s13, 63
    s_lshl_b32 s14, s13, 10
    s_add_u32 m0, s14, 65536
    s_lshl_b32 s13, s13, 13
    s_add_u32 s13, s13, s9
    buffer_load_dwordx4 v8, s[84:87], s13 offen lds
    s_add_u32 s13, s6, 56
    s_and_b32 s13, s13, 63
    s_lshl_b32 s14, s13, 10
    s_add_u32 m0, s14, 65536
    s_lshl_b32 s13, s13, 13
    s_add_u32 s13, s13, s9
    buffer_load_dwordx4 v8, s[84:87], s13 offen lds
    s_cmp_eq_u32 s3, 1
    s_cbranch_scc0 L_p_n9
    s_add_u32 s13, s6, 63
    s_and_b32 s13, s13, 63
    s_lshl_b32 s14, s13, 10
    s_add_u32 m0, s14, 65536
    s_lshl_b32 s13, s13, 13
    s_add_u32 s13, s13, s9
    buffer_load_dwordx4 v8, s[84:87], s13 offen lds
L_p_n9:
    s_waitcnt vmcnt(6)
    s_branch L_p_q
L_p_fin:
    ds_read_b128 v[152:155], v17 offset:6144
    ds_read_b128 v[156:159], v17 offset:7168
    ds_read_b128 v[160:163], v17 offset:10240
    ds_read_b128 v[164:167], v17 offset:11264
    ds_read_b128 v[168:171], v17 offset:14336
    ds_read_b128 v[172:175], v17 offset:15360
    ds_read_b128 v[176:179], v17 offset:18432
    ds_read_b128 v[180:183], v17 offset:19456
    ds_read_b128 v[184:187], v17 offset:22528
    ds_read_b128 v[188:191], v17 offset:23552
    ds_read_b128 v[192:195], v17 offset:26624
    ds_read_b128 v[196:199], v17 offset:27648
    ds_read_b128 v[200:203], v17 offset:30720
    ds_read_b128 v[204:207], v17 offset:31744
    v_lshlrev_b32 v11, 2, v1
    v_mov_b32 v10, 0
    s_lshl_b32 s13, s5, 7
    s_add_u32 s13, s13, s68
    v_writelane_b32 v10, s42, 0
    s_mov_b64 exec, 0xffffffff
    buffer_store_dword v10, v11, s[52:55], s13 offen sc1
    s_mov_b64 exec, -1
    s_waitcnt lgkmcnt(12)
    v_pk_add_f32 v[144:145], v[144:145], v[152:153]
    v_pk_add_f32 v[146:147], v[146:147], v[154:155]
    v_pk_add_f32 v[148:149], v[148:149], v[156:157]
    v_pk_add_f32 v[150:151], v[150:151], v[158:159]
    s_waitcnt lgkmcnt(10)
    v_pk_add_f32 v[144:145], v[144:145], v[160:161]
    v_pk_add_f32 v[146:147], v[146:147], v[162:163]
    v_pk_add_f32 v[148:149], v[148:149], v[164:165]
    v_pk_add_f32 v[150:151], v[150:151], v[166:167]
    s_waitcnt lgkmcnt(8)
    v_pk_add_f32 v[144:145], v[144:145], v[168:169]
    v_pk_add_f32 v[146:147], v[146:147], v[170:171]
    v_pk_add_f32 v[148:149], v[148:149], v[172:173]
    v_pk_add_f32 v[150:151], v[150:151], v[174:175]
    s_waitcnt lgkmcnt(6)
    v_pk_add_f32 v[144:145], v[144:145], v[176:177]
    v_pk_add_f32 v[146:147], v[146:147], v[178:179]
    v_pk_add_f32 v[148:149], v[148:149], v[180:181]
    v_pk_add_f32 v[150:151], v[150:151], v[182:183]
    s_waitcnt lgkmcnt(4)
    v_pk_add_f32 v[144:145], v[144:145], v[184:185]
    v_pk_add_f32 v[146:147], v[146:147], v[186:187]
    v_pk_add_f32 v[148:149], v[148:149], v[188:189]
    v_pk_add_f32 v[150:151], v[150:151], v[190:191]
    s_waitcnt lgkmcnt(2)
    v_pk_add_f32 v[144:145], v[144:145], v[192:193]
    v_pk_add_f32 v[146:147], v[146:147], v[194:195]
    v_pk_add_f32 v[148:149], v[148:149], v[196:197]
    v_pk_add_f32 v[150:151], v[150:151], v[198:199]
    s_waitcnt lgkmcnt(0)
    v_pk_add_f32 v[144:145], v[144:145], v[200:201]
    v_pk_add_f32 v[146:147], v[146:147], v[202:203]
    v_pk_add_f32 v[148:149], v[148:149], v[204:205]
    v_pk_add_f32 v[150:151], v[150:151], v[206:207]
    v_mov_b32 v152, v148
    v_mov_b32 v153, v149
    v_mov_b32 v154, v150
    s_nop 0
    v_permlane32_swap_b32 v148, v152
    v_permlane32_swap_b32 v149, v153
    v_permlane32_swap_b32 v150, v154
    s_nop 0
    v_add_f32 v148, v148, v152
    v_add_f32 v149, v149, v153
    v_add_f32 v150, v150, v154
    v_mov_b32 v152, v148
    v_mov_b32 v153, v149
    v_mov_b32 v154, v150
    s_nop 0
    v_permlane16_swap_b32 v148, v152
    v_permlane16_swap_b32 v149, v153
    v_permlane16_swap_b32 v150, v154
    s_nop 0
    v_add_f32 v148, v148, v152
    v_add_f32 v149, v149, v153
    v_add_f32 v150, v150, v154
    s_bitcmp1_b32 s5, 0
    s_cbranch_scc1 L_p_fv
    ds_bpermute_b32 v152, v18, v150 offset:0
    ds_bpermute_b32 v153, v18, v150 offset:4
    ds_bpermute_b32 v154, v18, v150 offset:8
    ds_bpermute_b32 v155, v18, v150 offset:12
    v_mul_f32 v148, 0x3b000000, v148
    v_mul_f32 v149, 0x3b000000, v149
    v_fma_f32 v149, -v148, v148, v149
    v_max_f32 v149, 0, v149
    v_add_f32 v149, 0x3727c5ac, v149
    v_rsq_f32 v149, v149
    s_waitcnt lgkmcnt(0)
    v_fma_f32 v144, -v148, v152, v144
    v_fma_f32 v145, -v148, v153, v145
    v_fma_f32 v146, -v148, v154, v146
    v_fma_f32 v147, -v148, v155, v147
    v_mul_f32 v144, v149, v144
    v_mul_f32 v145, v149, v145
    v_mul_f32 v146, v149, v146
    v_mul_f32 v147, v149, v147
    v_cvt_pk_bf16_f32 v12, v144, v145
    v_cvt_pk_bf16_f32 v13, v146, v147
    buffer_store_dwordx2 v[12:13], v19, s[52:55], s97 offen sc1
    s_barrier
    v_dot2c_f32_bf16 v109, v12, v12
    v_dot2c_f32_bf16 v109, v13, v13
    s_nop 2
    v_mov_b32 v11, v109
    s_nop 1
    v_permlane32_swap_b32 v109, v11
    s_nop 1
    v_add_f32 v109, v109, v11
    v_mov_b32 v11, v109
    s_nop 1
    v_permlane16_swap_b32 v109, v11
    s_nop 1
    v_add_f32 v109, v109, v11
    s_nop 1
    v_max_f32_dpp v109, v109, v109 row_ror:8 row_mask:0xf bank_mask:0xf
    s_nop 1
    v_max_f32_dpp v109, v109, v109 row_ror:4 row_mask:0xf bank_mask:0xf
    s_nop 1
    v_max_f32_dpp v109, v109, v109 row_ror:2 row_mask:0xf bank_mask:0xf
    s_nop 1
    v_max_f32_dpp v109, v109, v109 row_ror:1 row_mask:0xf bank_mask:0xf
    s_branch L_p_pub
L_p_fv:
    v_mul_f32 v148, 0x3b000000, v148
    v_mul_f32 v149, 0x3b000000, v149
    v_fma_f32 v149, -v148, v148, v149
    v_max_f32 v149, 0, v149
    v_add_f32 v149, 0x3727c5ac, v149
    v_rsq_f32 v149, v149
    s_nop 0
    ds_bpermute_b32 v152, v18, v148 offset:0
    ds_bpermute_b32 v156, v18, v149 offset:0
    ds_bpermute_b32 v153, v18, v148 offset:4
    ds_bpermute_b32 v157, v18, v149 offset:4
    ds_bpermute_b32 v154, v18, v148 offset:8
    ds_bpermute_b32 v158, v18, v149 offset:8
    ds_bpermute_b32 v155, v18, v148 offset:12
    ds_bpermute_b32 v159, v18, v149 offset:12
    s_waitcnt lgkmcnt(0)
    v_fma_f32 v144, -v152, v150, v144
    v_fma_f32 v145, -v153, v150, v145
    v_fma_f32 v146, -v154, v150, v146
    v_fma_f32 v147, -v155, v150, v147
    v_mul_f32 v144, v156, v144
    v_mul_f32 v145, v157, v145
    v_mul_f32 v146, v158, v146
    v_mul_f32 v147, v159, v147
    v_cvt_pk_bf16_f32 v12, v144, v145
    v_cvt_pk_bf16_f32 v13, v146, v147
    buffer_store_dwordx2 v[12:13], v19, s[52:55], s97 offen sc1
    s_barrier
L_p_pub:
    s_waitcnt vmcnt(2)
    v_add_u32 v108, 1, v108
L_p_q:
    ds_read_b128 v[128:131], v9
    v_xor_b32 v10, 16, v9
    ds_read_b128 v[132:135], v10
    v_xor_b32 v10, 32, v9
    ds_read_b128 v[136:139], v10
    v_xor_b32 v10, 48, v9
    ds_read_b128 v[140:143], v10
    v_xor_b32 v10, 64, v9
    ds_read_b128 v[144:147], v10
    v_xor_b32 v10, 80, v9
    ds_read_b128 v[148:151], v10
    v_xor_b32 v10, 96, v9
    ds_read_b128 v[152:155], v10
    v_xor_b32 v10, 112, v9
    ds_read_b128 v[156:159], v10
    s_waitcnt lgkmcnt(7)
    v_dot2c_f32_bf16 v96, s83, v128
    v_dot2c_f32_bf16 v97, v128, v128
    v_dot2c_f32_bf16 v98, s83, v129
    v_dot2c_f32_bf16 v99, v129, v129
    v_dot2c_f32_bf16 v96, s83, v130
    v_dot2c_f32_bf16 v97, v130, v130
    v_dot2c_f32_bf16 v98, s83, v131
    v_dot2c_f32_bf16 v99, v131, v131
    s_waitcnt lgkmcnt(6)
    v_dot2c_f32_bf16 v96, s83, v132
    v_dot2c_f32_bf16 v97, v132, v132
    v_dot2c_f32_bf16 v98, s83, v133
    v_dot2c_f32_bf16 v99, v133, v133
    v_dot2c_f32_bf16 v96, s83, v134
    v_dot2c_f32_bf16 v97, v134, v134
    v_dot2c_f32_bf16 v98, s83, v135
    v_dot2c_f32_bf16 v99, v135, v135
    s_waitcnt lgkmcnt(5)
    v_dot2c_f32_bf16 v96, s83, v136
    v_dot2c_f32_bf16 v97, v136, v136
    v_dot2c_f32_bf16 v98, s83, v137
    v_dot2c_f32_bf16 v99, v137, v137
    v_dot2c_f32_bf16 v96, s83, v138
    v_dot2c_f32_bf16 v97, v138, v138
    v_dot2c_f32_bf16 v98, s83, v139
    v_dot2c_f32_bf16 v99, v139, v139
    s_waitcnt lgkmcnt(4)
    v_dot2c_f32_bf16 v96, s83, v140
    v_dot2c_f32_bf16 v97, v140, v140
    v_dot2c_f32_bf16 v98, s83, v141
    v_dot2c_f32_bf16 v99, v141, v141
    v_dot2c_f32_bf16 v96, s83, v142
    v_dot2c_f32_bf16 v97, v142, v142
    v_dot2c_f32_bf16 v98, s83, v143
    v_dot2c_f32_bf16 v99, v143, v143
    s_waitcnt lgkmcnt(3)
    v_dot2c_f32_bf16 v96, s83, v144
    v_dot2c_f32_bf16 v97, v144, v144
    v_dot2c_f32_bf16 v98, s83, v145
    v_dot2c_f32_bf16 v99, v145, v145
    v_dot2c_f32_bf16 v96, s83, v146
    v_dot2c_f32_bf16 v97, v146, v146
    v_dot2c_f32_bf16 v98, s83, v147
    v_dot2c_f32_bf16 v99, v147, v147
    s_waitcnt lgkmcnt(2)
    v_dot2c_f32_bf16 v96, s83, v148
    v_dot2c_f32_bf16 v97, v148, v148
    v_dot2c_f32_bf16 v98, s83, v149
    v_dot2c_f32_bf16 v99, v149, v149
    v_dot2c_f32_bf16 v96, s83, v150
    v_dot2c_f32_bf16 v97, v150, v150
    v_dot2c_f32_bf16 v98, s83, v151
    v_dot2c_f32_bf16 v99, v151, v151
    s_waitcnt lgkmcnt(1)
    v_dot2c_f32_bf16 v96, s83, v152
    v_dot2c_f32_bf16 v97, v152, v152
    v_dot2c_f32_bf16 v98, s83, v153
    v_dot2c_f32_bf16 v99, v153, v153
    v_dot2c_f32_bf16 v96, s83, v154
    v_dot2c_f32_bf16 v97, v154, v154
    v_dot2c_f32_bf16 v98, s83, v155
    v_dot2c_f32_bf16 v99, v155, v155
    s_waitcnt lgkmcnt(0)
    v_dot2c_f32_bf16 v96, s83, v156
    v_dot2c_f32_bf16 v97, v156, v156
    v_dot2c_f32_bf16 v98, s83, v157
    v_dot2c_f32_bf16 v99, v157, v157
    v_dot2c_f32_bf16 v96, s83, v158
    v_dot2c_f32_bf16 v97, v158, v158
    v_dot2c_f32_bf16 v98, s83, v159
    v_dot2c_f32_bf16 v99, v159, v159
    s_nop 2
    v_pk_add_f32 v[96:97], v[96:97], v[98:99]
    ds_write_b64 v101, v[96:97]
    s_waitcnt vmcnt(0)
    s_cmp_eq_u32 s3, 0
    s_cbranch_scc0 L_p_f1
    s_waitcnt vmcnt(0)
    s_mov_b64 exec, 1
    buffer_store_dwordx2 v[108:109], v3, s[52:55], s82 offen sc1
    s_mov_b64 exec, -1
    s_setprio 0
L_p_f1:
    s_waitcnt lgkmcnt(0)
    s_barrier
    ds_read_b128 v[128:131], v112 offset:0
    ds_read_b64_tr_b16 v[132:133], v116 offset:0
    ds_read_b64_tr_b16 v[134:135], v116 offset:512
    ds_read_b128 v[136:139], v113 offset:0
    ds_read_b64_tr_b16 v[140:141], v117 offset:0
    ds_read_b64_tr_b16 v[142:143], v117 offset:512
    ds_read_b128 v[144:147], v114 offset:0
    ds_read_b64_tr_b16 v[148:149], v118 offset:0
    ds_read_b64_tr_b16 v[150:151], v118 offset:512
    ds_read_b128 v[152:155], v115 offset:0
    ds_read_b64_tr_b16 v[156:157], v119 offset:0
    ds_read_b64_tr_b16 v[158:159], v119 offset:512
    s_waitcnt lgkmcnt(9)
    v_mfma_f32_32x32x16_bf16 v[44:59], v[132:135], v[128:131], 0
    ds_read_b128 v[160:163], v112 offset:8192
    ds_read_b64_tr_b16 v[164:165], v116 offset:8192
    ds_read_b64_tr_b16 v[166:167], v116 offset:8704
    v_mfma_f32_16x16x32_bf16 v[96:99], v[120:123], v[132:135], 0
    s_mov_b32 s48, s24
    s_and_b32 s49, s25, 0xffff
    s_mov_b32 s50, 0x80000
    s_mov_b32 s51, 0x00020000
    s_mov_b32 s56, s32
    s_and_b32 s57, s33, 0xffff
    s_mov_b32 s58, 0x158000
    s_mov_b32 s59, 0x00020000
    s_lshl_b32 s69, s3, 14
    s_waitcnt lgkmcnt(9)
    v_mfma_f32_32x32x16_bf16 v[44:59], v[140:143], v[136:139], v[44:59]
    ds_read_b128 v[168:171], v113 offset:8192
    ds_read_b64_tr_b16 v[172:173], v117 offset:8192
    ds_read_b64_tr_b16 v[174:175], v117 offset:8704
    v_mfma_f32_16x16x32_bf16 v[96:99], v[120:123], v[140:143], v[96:99]
    s_lshl_b32 s12, s5, 7
    s_add_u32 s69, s69, s12
    s_lshr_b32 s12, s2, 3
    s_lshl_b32 s12, s12, 3
    s_add_u32 s12, s12, s3
    s_mul_i32 s62, s12, 3
    s_lshl_b32 s63, s4, 1
    s_add_u32 s63, s63, s72
    s_lshl_b32 s63, s63, 5
    s_waitcnt lgkmcnt(9)
    v_mfma_f32_32x32x16_bf16 v[44:59], v[148:151], v[144:147], v[44:59]
    ds_read_b128 v[176:179], v114 offset:8192
    ds_read_b64_tr_b16 v[180:181], v118 offset:8192
    ds_read_b64_tr_b16 v[182:183], v118 offset:8704
    s_lshl_b32 s12, s5, 2
    s_add_u32 s63, s63, s12
    s_and_b32 s12, s3, 3
    s_add_u32 s63, s63, s12
    s_lshl_b32 s63, s63, 10
    s_lshl_b32 s73, s5, 1
    s_add_u32 s73, s73, s70
    s_lshl_b32 s73, s73, 1
    s_add_u32 s73, s73, s72
    s_waitcnt lgkmcnt(9)
    v_mfma_f32_32x32x16_bf16 v[44:59], v[156:159], v[152:155], v[44:59]
    ds_read_b128 v[184:187], v115 offset:8192
    ds_read_b64_tr_b16 v[188:189], v119 offset:8192
    ds_read_b64_tr_b16 v[190:191], v119 offset:8704
    s_lshl_b32 s75, s4, 1
    s_add_u32 s75, s75, s71
    s_lshl_b32 s74, s75, 15
    s_lshl_b32 s12, s73, 5
    s_add_u32 s74, s74, s12
    s_lshl_b32 s100, s75, 5
    s_add_u32 s100, s100, s73
    s_lshl_b32 s100, s100, 10
    s_add_u32 s100, s100, 0x800000
    s_waitcnt lgkmcnt(9)
    v_mfma_f32_32x32x16_bf16 v[44:59], v[164:167], v[160:163], v[44:59]
    ds_read_b128 v[192:195], v112 offset:16384
    ds_read_b64_tr_b16 v[196:197], v116 offset:16384
    ds_read_b64_tr_b16 v[198:199], v116 offset:16896
    v_mfma_f32_16x16x32_bf16 v[96:99], v[120:123], v[164:167], v[96:99]
    s_and_b32 s99, s70, s72
    s_lshl_b32 s101, s4, 1
    s_add_u32 s101, s101, s99
    s_mul_i32 s101, s101, 86
    s_lshl_b32 s12, s65, 1
    s_add_u32 s101, s101, s12
    s_lshl_b32 s101, s101, 10
    s_add_u32 s101, s101, 0xa00000
    s_lshr_b32 s12, s67, 22
    s_waitcnt lgkmcnt(9)
    v_mfma_f32_32x32x16_bf16 v[44:59], v[172:175], v[168:171], v[44:59]
    ds_read_b128 v[200:203], v113 offset:16384
    ds_read_b64_tr_b16 v[204:205], v117 offset:16384
    ds_read_b64_tr_b16 v[206:207], v117 offset:16896
    v_mfma_f32_16x16x32_bf16 v[96:99], v[120:123], v[172:175], v[96:99]
    s_lshl_b32 s12, s12, 25
    s_add_u32 s101, s101, s12
    s_xor_b32 s64, s72, 1
    s_mul_i32 s64, s64, 88064
    s_add_u32 s64, s64, s101
    s_lshl_b32 s95, s4, 14
    s_lshl_b32 s12, s5, 11
    s_add_u32 s95, s95, s12
    s_lshl_b32 s12, s70, 10
    s_waitcnt lgkmcnt(9)
    v_mfma_f32_32x32x16_bf16 v[44:59], v[180:183], v[176:179], v[44:59]
    ds_read_b128 v[208:211], v114 offset:16384
    ds_read_b64_tr_b16 v[212:213], v118 offset:16384
    ds_read_b64_tr_b16 v[214:215], v118 offset:16896
    s_add_u32 s95, s95, s12
    s_add_u32 s95, s95, 0x440000
    s_mov_b32 s84, s30
    s_and_b32 s85, s31, 0xffff
    s_mov_b32 s86, 0xac0
    s_mov_b32 s87, 0x00020000
    s_mov_b32 s88, s34
    s_and_b32 s89, s35, 0xffff
    ds_read2st64_b64 v[128:131], v104 offset0:0 offset1:8
    ds_read2st64_b64 v[132:135], v104 offset0:16 offset1:24
    ds_read2st64_b64 v[136:139], v104 offset0:32 offset1:40
    ds_read2st64_b64 v[140:143], v104 offset0:48 offset1:56
    s_waitcnt lgkmcnt(13)
    v_mfma_f32_32x32x16_bf16 v[44:59], v[188:191], v[184:187], v[44:59]
    ds_read_b128 v[216:219], v115 offset:16384
    ds_read_b64_tr_b16 v[220:221], v119 offset:16384
    ds_read_b64_tr_b16 v[222:223], v119 offset:16896
    s_mov_b32 s90, 0x400
    s_mov_b32 s91, 0x00020000
    s_mov_b32 s20, s36
    s_and_b32 s21, s37, 0xffff
    s_mov_b32 s22, 0x200000
    s_mov_b32 s23, 0x00020000
    s_lshl_b32 s6, s3, 12
    s_lshl_b32 s7, s4, 16
    s_waitcnt lgkmcnt(13)
    v_mfma_f32_32x32x16_bf16 v[44:59], v[196:199], v[192:195], v[44:59]
    ds_read_b128 v[224:227], v112 offset:24576
    ds_read_b64_tr_b16 v[228:229], v116 offset:24576
    ds_read_b64_tr_b16 v[230:231], v116 offset:25088
    v_mfma_f32_16x16x32_bf16 v[96:99], v[120:123], v[196:199], v[96:99]
    s_add_u32 s7, s7, s6
    s_lshl_b32 s12, s3, 3
    s_mov_b64 s[8:9], 0xff
    s_lshl_b64 s[8:9], s[8:9], s12
    s_add_u32 s12, s3, 2
    s_lshr_b32 s12, s12, 3
    s_add_u32 s12, s12, s3
    s_max_u32 s15, s12, 1
    s_waitcnt lgkmcnt(13)
    v_mfma_f32_32x32x16_bf16 v[44:59], v[204:207], v[200:203], v[44:59]
    ds_read_b128 v[232:235], v113 offset:24576
    ds_read_b64_tr_b16 v[236:237], v117 offset:24576
    ds_read_b64_tr_b16 v[238:239], v117 offset:25088
    v_mfma_f32_16x16x32_bf16 v[96:99], v[120:123], v[204:207], v[96:99]
    s_sub_u32 s15, s15, 1
    s_lshl_b32 s15, s15, 3
    s_min_u32 s12, s12, 1
    s_mul_i32 s12, s12, 0xff00
    s_or_b32 s18, s12, 0xff
    s_mov_b32 s19, 0
    s_lshl_b64 s[18:19], s[18:19], s15
    s_lshl_b32 s24, s5, 7
    s_waitcnt lgkmcnt(13)
    v_mfma_f32_32x32x16_bf16 v[44:59], v[212:215], v[208:211], v[44:59]
    ds_read_b128 v[240:243], v114 offset:24576
    ds_read_b64_tr_b16 v[244:245], v118 offset:24576
    ds_read_b64_tr_b16 v[246:247], v118 offset:25088
    s_lshl_b32 s12, s3, 2
    s_add_u32 s24, s24, s12
    s_add_u32 s24, s24, s68
    s_lshl_b32 s26, s4, 14
    s_add_u32 s26, s26, 0x440000
    s_lshl_b32 s12, s73, 9
    s_add_u32 s25, s26, s12
    s_lshl_b32 s12, s71, 8
    s_cmp_lt_u32 s3, 4
    s_cbranch_scc1 L_p_e1
    buffer_load_dwordx2 v[14:15], v111, s[52:55], s82 offen sc1
L_p_e1:
    s_waitcnt lgkmcnt(9)
    v_mfma_f32_32x32x16_bf16 v[44:59], v[220:223], v[216:219], v[44:59]
    ds_read_b128 v[248:251], v115 offset:24576
    ds_read_b64_tr_b16 v[252:253], v119 offset:24576
    ds_read_b64_tr_b16 v[254:255], v119 offset:25088
    s_add_u32 s25, s25, s12
    s_lshl_b32 s27, s3, 11
    s_add_u32 s26, s26, s27
    s_add_u32 s27, s27, 131072
    s_mul_i32 s28, s4, 176128
    s_add_u32 s28, s28, 0xa00000
    s_mul_i32 s12, s3, 11264
    s_add_u32 s28, s28, s12
    s_waitcnt lgkmcnt(9)
    v_mfma_f32_32x32x16_bf16 v[44:59], v[228:231], v[224:227], v[44:59]
    v_mfma_f32_16x16x32_bf16 v[96:99], v[120:123], v[228:231], v[96:99]
    s_lshr_b32 s98, s3, 1
    s_mul_i32 s97, s98, 180224
    s_lshl_b32 s12, s5, 7
    s_add_u32 s97, s97, s12
    s_lshl_b32 s12, s70, 6
    s_add_u32 s97, s97, s12
    s_lshl_b32 s12, s72, 5
    s_xor_b32 s39, s66, s12
    s_waitcnt lgkmcnt(15)
    v_add_f32 v128, v128, v136
    v_add_f32 v129, v129, v137
    v_add_f32 v130, v130, v138
    v_add_f32 v131, v131, v139
    v_add_f32 v132, v132, v140
    v_add_f32 v133, v133, v141
    v_add_f32 v134, v134, v142
    v_add_f32 v135, v135, v143
    s_waitcnt lgkmcnt(6)
    v_mfma_f32_32x32x16_bf16 v[44:59], v[236:239], v[232:235], v[44:59]
    v_mfma_f32_16x16x32_bf16 v[96:99], v[120:123], v[236:239], v[96:99]
    s_lshl_b32 s12, s72, 16
    s_xor_b32 s38, s39, s12
    s_lshl_b32 s12, s70, 14
    s_xor_b32 s38, s38, s12
    s_xor_b32 s39, s39, s10
    s_lshl_b32 s32, s71, 16
    s_lshl_b32 s12, s72, 14
    s_add_u32 s32, s32, s12
    v_add_f32 v128, v128, v132
    v_add_f32 v129, v129, v133
    v_add_f32 v130, v130, v134
    v_add_f32 v131, v131, v135
    v_add_f32 v128, v128, v130
    v_add_f32 v129, v129, v131
    s_waitcnt lgkmcnt(3)
    v_mfma_f32_32x32x16_bf16 v[44:59], v[244:247], v[240:243], v[44:59]
    s_add_u32 s32, s32, 32768
    s_lshl_b32 s33, s99, 16
    s_add_u32 s33, s33, 32768
    s_lshl_b32 s29, s99, 8
    s_add_u32 s29, s29, 131072
    s_lshl_b32 s96, s99, 12
    s_add_u32 s96, s96, 32768
    s_lshl_b32 s16, s71, 13
    v_mul_f32 v128, 0x3b000000, v128
    v_mul_f32 v129, 0x3b000000, v129
    v_fma_f32 v129, -v128, v128, v129
    v_max_f32 v129, 0, v129
    v_add_f32 v129, 0x3727c5ac, v129
    v_rsq_f32 v129, v129
    s_waitcnt lgkmcnt(0)
    v_mfma_f32_32x32x16_bf16 v[44:59], v[252:255], v[248:251], v[44:59]
    s_lshl_b32 s12, s98, 10
    s_add_u32 s16, s16, s12
    s_lshl_b32 s17, s73, 5
    s_lshl_b32 s38, s72, 5
    s_lshl_b32 s12, s70, 14
    s_add_u32 s38, s38, s12
    s_lshl_b32 s32, s71, 16
    s_add_u32 s32, s32, 32768
    s_nop 3
    s_mov_b64 exec, 0xffff
    ds_write_b32 v106, v96 offset:512
    ds_write_b32 v106, v97 offset:576
    s_mov_b64 exec, -1
    v_mul_f32 v130, 0x3eb8aa3b, v129
    s_nop 2
    ds_write_b128 v17, v[52:55] offset:2048
    ds_write_b128 v17, v[56:59] offset:3072
    s_cmp_lt_u32 s3, 4
    s_cbranch_scc1 L_p_np
    s_mov_b32 s13, 0
    s_branch L_p_chk
L_p_poll:
    buffer_load_dwordx2 v[14:15], v111, s[52:55], s82 offen sc1
    s_add_u32 s13, s13, 1
    s_cmp_gt_u32 s13, 1048576
    s_cbranch_scc1 L_p_out
L_p_chk:
    s_waitcnt vmcnt(0)
    v_cmp_eq_u32 vcc, v14, v108
    s_cbranch_vccnz L_p_poll
L_p_out:
    s_waitcnt vmcnt(0)
    v_max_f32_dpp v15, v15, v15 row_ror:8 row_mask:0xf bank_mask:0xf
    s_nop 1
    v_max_f32_dpp v15, v15, v15 row_ror:4 row_mask:0xf bank_mask:0xf
    s_nop 1
    v_max_f32_dpp v15, v15, v15 row_ror:2 row_mask:0xf bank_mask:0xf
    s_nop 1
    v_max_f32_dpp v15, v15, v15 row_ror:1 row_mask:0xf bank_mask:0xf
    s_nop 1
    ds_write_b32 v100, v15
L_p_np:
    s_waitcnt lgkmcnt(0)
    s_barrier
    ds_read_b128 v[136:139], v103 offset:2048
    ds_read_b128 v[140:143], v103 offset:3072
    ds_read_b128 v[144:147], v105 offset:512
    ds_read_b128 v[148:151], v105 offset:544
    ds_read_b128 v[152:155], v107 offset:4608
    ds_read_b128 v[156:159], v107 offset:4640
    ds_read_b128 v[160:163], v105 offset:16896
    ds_read_b128 v[164:167], v105 offset:16928
    ds_read_b128 v[168:171], v107 offset:20992
    ds_read_b128 v[172:175], v107 offset:21024
    ds_read_b32 v38, v95
    s_add_u32 s11, s10, 0x200000
    s_add_u32 m0, s10, 0
    s_add_u32 s13, s11, 0
    buffer_load_dwordx4 v3, s[52:55], s13 offen sc1 lds
    s_add_u32 m0, s10, 65536
    s_add_u32 s13, s11, 65536
    buffer_load_dwordx4 v3, s[52:55], s13 offen sc1 lds
    s_waitcnt lgkmcnt(9)
    v_pk_add_f32 v[44:45], v[44:45], v[136:137]
    v_pk_add_f32 v[46:47], v[46:47], v[138:139]
    v_pk_add_f32 v[48:49], v[48:49], v[140:141]
    v_pk_add_f32 v[50:51], v[50:51], v[142:143]
    s_waitcnt lgkmcnt(5)
    v_pk_add_f32 v[144:145], v[144:145], v[152:153]
    v_pk_add_f32 v[146:147], v[146:147], v[154:155]
    v_pk_add_f32 v[148:149], v[148:149], v[156:157]
    v_pk_add_f32 v[150:151], v[150:151], v[158:159]
    s_waitcnt lgkmcnt(0)
    v_pk_add_f32 v[160:161], v[160:161], v[168:169]
    v_pk_add_f32 v[162:163], v[162:163], v[170:171]
    v_pk_add_f32 v[164:165], v[164:165], v[172:173]
    v_pk_add_f32 v[166:167], v[166:167], v[174:175]
    v_pk_add_f32 v[144:145], v[144:145], v[160:161]
    v_pk_add_f32 v[146:147], v[146:147], v[162:163]
    v_pk_add_f32 v[148:149], v[148:149], v[164:165]
    v_pk_add_f32 v[150:151], v[150:151], v[166:167]
    v_pk_fma_f32 v[44:45], v[128:129], v[144:145], v[44:45] op_sel_hi:[0,1,1] neg_lo:[1,0,0] neg_hi:[1,0,0]
    v_pk_fma_f32 v[46:47], v[128:129], v[146:147], v[46:47] op_sel_hi:[0,1,1] neg_lo:[1,0,0] neg_hi:[1,0,0]
    v_pk_fma_f32 v[48:49], v[128:129], v[148:149], v[48:49] op_sel_hi:[0,1,1] neg_lo:[1,0,0] neg_hi:[1,0,0]
    v_pk_fma_f32 v[50:51], v[128:129], v[150:151], v[50:51] op_sel_hi:[0,1,1] neg_lo:[1,0,0] neg_hi:[1,0,0]
    v_pk_mul_f32 v[44:45], v[130:131], v[44:45] op_sel_hi:[0,1]
    v_pk_mul_f32 v[46:47], v[130:131], v[46:47] op_sel_hi:[0,1]
    v_pk_mul_f32 v[48:49], v[130:131], v[48:49] op_sel_hi:[0,1]
    v_pk_mul_f32 v[50:51], v[130:131], v[50:51] op_sel_hi:[0,1]
    v_cvt_pk_bf16_f32 v4, v44, v45
    v_cvt_pk_bf16_f32 v5, v46, v47
    v_cvt_pk_bf16_f32 v6, v48, v49
    v_cvt_pk_bf16_f32 v7, v50, v51
    ds_write_b128 v17, v[4:7] offset:1024
    v_dot2c_f32_bf16 v36, v4, v4
    v_dot2c_f32_bf16 v36, v5, v5
    v_dot2c_f32_bf16 v36, v6, v6
    v_dot2c_f32_bf16 v36, v7, v7
    v_max_f32_dpp v38, v38, v38 row_ror:8 row_mask:0xf bank_mask:0xf
    s_nop 1
    v_max_f32_dpp v38, v38, v38 row_ror:4 row_mask:0xf bank_mask:0xf
    s_nop 1
    v_mov_b32 v37, v36
    v_max_f32_dpp v38, v38, v38 row_ror:2 row_mask:0xf bank_mask:0xf
    s_nop 0
    v_permlane32_swap_b32 v36, v37
    v_max_f32_dpp v38, v38, v38 row_ror:1 row_mask:0xf bank_mask:0xf
    v_add_f32 v36, v36, v37
    s_nop 0
    ds_write_b32 v106, v36 offset:768
    s_add_u32 m0, s10, 8192
    s_add_u32 s13, s11, 8192
    buffer_load_dwordx4 v3, s[52:55], s13 offen sc1 lds
    s_add_u32 m0, s10, 73728
    s_add_u32 s13, s11, 73728
    buffer_load_dwordx4 v3, s[52:55], s13 offen sc1 lds
    s_cmp_eq_u32 s3, 0
    s_cbranch_scc0 L_fl2
    v_add_u32 v108, 1, v108
    s_mov_b64 exec, 1
    buffer_store_dword v108, v3, s[52:55], s82 offen sc1
    s_mov_b64 exec, -1
L_fl2:
    s_waitcnt lgkmcnt(0)
    s_barrier
    ds_read_b32 v37, v102 offset:768
    ds_read_b128 v[8:11], v110 offset:1024
    s_waitcnt lgkmcnt(1)
    v_max_f32 v36, v36, v37
    v_mul_f32 v36, v36, v38
    v_sqrt_f32 v37, v36
    s_waitcnt lgkmcnt(0)
    s_mov_b32 s82, 0x07060302
    v_cmp_nge_f32 vcc, 0x42200000, v37
    s_cmp_eq_u64 vcc, 0
    s_cbranch_scc0 L_k2_slow
    v_sub_f32 v44, 0, v37
    v_sub_f32 v45, 0, v37
    v_sub_f32 v46, 0, v37
    v_sub_f32 v47, 0, v37
    v_sub_f32 v48, 0, v37
    v_sub_f32 v49, 0, v37
    v_sub_f32 v50, 0, v37
    v_sub_f32 v51, 0, v37
    v_sub_f32 v52, 0, v37
    v_sub_f32 v53, 0, v37
    v_sub_f32 v54, 0, v37
    v_sub_f32 v55, 0, v37
    v_sub_f32 v56, 0, v37
    v_sub_f32 v57, 0, v37
    v_sub_f32 v58, 0, v37
    v_sub_f32 v59, 0, v37
    s_waitcnt vmcnt(2)
    s_barrier
    ds_read_b128 v[12:15], v2
    s_mov_b64 exec, s[60:61]
    ds_read_b128 v[20:23], v2 offset:1024
    ds_read_b128 v[24:27], v2 offset:768
    s_mov_b64 exec, -1
    s_waitcnt lgkmcnt(0)
    v_mfma_f32_32x32x16_bf16 v[92:107], v[12:15], v[4:7], v[44:59]
    s_nop 7
    s_nop 3
    s_setprio 3
    v_exp_f32 v92, v92
    v_exp_f32 v93, v93
    s_mov_b64 exec, s[60:61]
    ds_read_b128 v[28:31], v2 offset:3072
    ds_read_b128 v[32:35], v2 offset:2816
    s_mov_b64 exec, -1
    s_add_u32 m0, s10, 16384
    s_add_u32 s13, s11, 16384
    buffer_load_dwordx4 v3, s[52:55], s13 offen sc1 lds
    s_add_u32 m0, s10, 81920
    s_add_u32 s13, s11, 81920
    buffer_load_dwordx4 v3, s[52:55], s13 offen sc1 lds
    v_exp_f32 v94, v94
    v_exp_f32 v95, v95
    v_exp_f32 v96, v96
    v_mfma_f32_32x32x16_bf16 v[108:123], v[12:15], v[8:11], v[44:59]
    ds_read_b128 v[16:19], v2 offset:2048
    v_exp_f32 v97, v97
    v_exp_f32 v98, v98
    v_exp_f32 v99, v99
    v_exp_f32 v100, v100
    v_exp_f32 v101, v101
    v_smfmac_f32_32x32x32_bf16 v[60:75], v[20:23], v[92:99], v43
    v_exp_f32 v102, v102
    v_exp_f32 v103, v103
    v_exp_f32 v104, v104
    v_exp_f32 v105, v105
    v_exp_f32 v106, v106
    v_exp_f32 v107, v107
    v_exp_f32 v108, v108
    v_exp_f32 v109, v109
    v_smfmac_f32_32x32x32_bf16 v[60:75], v[24:27], v[100:107], v43
    v_exp_f32 v110, v110
    v_exp_f32 v111, v111
    v_exp_f32 v112, v112
    s_waitcnt lgkmcnt(0)
    v_mfma_f32_32x32x16_bf16 v[92:107], v[16:19], v[4:7], v[44:59]
    s_add_u32 m0, s10, 49152
    s_add_u32 s13, s67, 0
    buffer_load_dwordx4 v125, s[44:47], s13 offen lds
    s_add_u32 m0, s10, 114688
    s_add_u32 s13, s67, 176128
    buffer_load_dwordx4 v125, s[44:47], s13 offen lds
    v_exp_f32 v113, v113
    v_exp_f32 v114, v114
    v_exp_f32 v115, v115
    v_exp_f32 v116, v116
    v_exp_f32 v117, v117
    v_smfmac_f32_32x32x32_bf16 v[76:91], v[20:23], v[108:115], v43
    v_exp_f32 v118, v118
    v_exp_f32 v119, v119
    v_exp_f32 v120, v120
    v_exp_f32 v121, v121
    v_exp_f32 v122, v122
    v_exp_f32 v123, v123
    s_setprio 2
    v_exp_f32 v92, v92
    v_exp_f32 v93, v93
    v_smfmac_f32_32x32x32_bf16 v[76:91], v[24:27], v[116:123], v43
    s_mov_b64 exec, s[60:61]
    ds_read_b128 v[20:23], v2 offset:5120
    ds_read_b128 v[24:27], v2 offset:4864
    s_mov_b64 exec, -1
    s_add_u32 m0, s10, 24576
    s_add_u32 s13, s11, 24576
    buffer_load_dwordx4 v3, s[52:55], s13 offen sc1 lds
    s_add_u32 m0, s10, 90112
    s_add_u32 s13, s11, 90112
    buffer_load_dwordx4 v3, s[52:55], s13 offen sc1 lds
    v_exp_f32 v94, v94
    v_exp_f32 v95, v95
    v_exp_f32 v96, v96
    v_mfma_f32_32x32x16_bf16 v[108:123], v[16:19], v[8:11], v[44:59]
    ds_read_b128 v[12:15], v2 offset:4096
    v_exp_f32 v97, v97
    v_exp_f32 v98, v98
    v_exp_f32 v99, v99
    v_exp_f32 v100, v100
    v_exp_f32 v101, v101
    v_smfmac_f32_32x32x32_bf16 v[60:75], v[28:31], v[92:99], v43
    v_exp_f32 v102, v102
    v_exp_f32 v103, v103
    v_exp_f32 v104, v104
    v_exp_f32 v105, v105
    v_exp_f32 v106, v106
    v_exp_f32 v107, v107
    v_exp_f32 v108, v108
    v_exp_f32 v109, v109
    v_smfmac_f32_32x32x32_bf16 v[60:75], v[32:35], v[100:107], v43
    v_exp_f32 v110, v110
    v_exp_f32 v111, v111
    v_exp_f32 v112, v112
    s_waitcnt lgkmcnt(0)
    v_mfma_f32_32x32x16_bf16 v[92:107], v[12:15], v[4:7], v[44:59]
    s_add_u32 m0, s10, 57344
    s_add_u32 s13, s67, 352256
    buffer_load_dwordx4 v125, s[44:47], s13 offen lds
    s_add_u32 m0, s10, 122880
    s_add_u32 s13, s67, 528384
    buffer_load_dwordx4 v125, s[44:47], s13 offen lds
    v_exp_f32 v113, v113
    v_exp_f32 v114, v114
    v_exp_f32 v115, v115
    v_exp_f32 v116, v116
    v_exp_f32 v117, v117
    v_smfmac_f32_32x32x32_bf16 v[76:91], v[28:31], v[108:115], v43
    v_exp_f32 v118, v118
    v_exp_f32 v119, v119
    v_exp_f32 v120, v120
    v_exp_f32 v121, v121
    v_exp_f32 v122, v122
    v_exp_f32 v123, v123
    s_setprio 1
    v_exp_f32 v92, v92
    v_exp_f32 v93, v93
    v_smfmac_f32_32x32x32_bf16 v[76:91], v[32:35], v[116:123], v43
    s_mov_b64 exec, s[60:61]
    ds_read_b128 v[28:31], v2 offset:7168
    ds_read_b128 v[32:35], v2 offset:6912
    s_mov_b64 exec, -1
    v_exp_f32 v94, v94
    v_exp_f32 v95, v95
    v_exp_f32 v96, v96
    v_mfma_f32_32x32x16_bf16 v[108:123], v[12:15], v[8:11], v[44:59]
    ds_read_b128 v[16:19], v2 offset:6144
    v_exp_f32 v97, v97
    v_exp_f32 v98, v98
    v_exp_f32 v99, v99
    v_exp_f32 v100, v100
    v_exp_f32 v101, v101
    v_smfmac_f32_32x32x32_bf16 v[60:75], v[20:23], v[92:99], v43
    v_exp_f32 v102, v102
    v_exp_f32 v103, v103
    v_exp_f32 v104, v104
    v_exp_f32 v105, v105
    v_exp_f32 v106, v106
    v_exp_f32 v107, v107
    s_setprio 0
    v_exp_f32 v108, v108
    v_exp_f32 v109, v109
    v_smfmac_f32_32x32x32_bf16 v[60:75], v[24:27], v[100:107], v43
    v_exp_f32 v110, v110
    v_exp_f32 v111, v111
    v_exp_f32 v112, v112
    s_waitcnt lgkmcnt(0)
    v_mfma_f32_32x32x16_bf16 v[92:107], v[16:19], v[4:7], v[44:59]
    s_add_u32 m0, s66, 0
    s_add_u32 s13, s67, 704512
    buffer_load_dwordx4 v125, s[44:47], s13 offen lds
    s_add_u32 m0, s66, 1024
    s_add_u32 s13, s67, 880640
    buffer_load_dwordx4 v125, s[44:47], s13 offen lds
    v_exp_f32 v113, v113
    v_exp_f32 v114, v114
    v_exp_f32 v115, v115
    v_exp_f32 v116, v116
    v_exp_f32 v117, v117
    v_smfmac_f32_32x32x32_bf16 v[76:91], v[20:23], v[108:115], v43
    v_exp_f32 v118, v118
    v_exp_f32 v119, v119
    v_exp_f32 v120, v120
    v_exp_f32 v121, v121
    v_exp_f32 v122, v122
    v_exp_f32 v123, v123
    s_waitcnt vmcnt(4)
    s_barrier
    s_setprio 3
    v_exp_f32 v92, v92
    v_exp_f32 v93, v93
    v_smfmac_f32_32x32x32_bf16 v[76:91], v[24:27], v[116:123], v43
    s_mov_b64 exec, s[60:61]
    ds_read_b128 v[20:23], v2 offset:9216
    ds_read_b128 v[24:27], v2 offset:8960
    s_mov_b64 exec, -1
    v_exp_f32 v94, v94
    v_exp_f32 v95, v95
    v_exp_f32 v96, v96
    v_mfma_f32_32x32x16_bf16 v[108:123], v[16:19], v[8:11], v[44:59]
    ds_read_b128 v[12:15], v2 offset:8192
    v_exp_f32 v97, v97
    v_exp_f32 v98, v98
    v_exp_f32 v99, v99
    v_exp_f32 v100, v100
    v_exp_f32 v101, v101
    v_smfmac_f32_32x32x32_bf16 v[60:75], v[28:31], v[92:99], v43
    v_exp_f32 v102, v102
    v_exp_f32 v103, v103
    v_exp_f32 v104, v104
    v_exp_f32 v105, v105
    v_exp_f32 v106, v106
    v_exp_f32 v107, v107
    v_exp_f32 v108, v108
    v_exp_f32 v109, v109
    v_smfmac_f32_32x32x32_bf16 v[60:75], v[32:35], v[100:107], v43
    v_exp_f32 v110, v110
    v_exp_f32 v111, v111
    v_exp_f32 v112, v112
    s_waitcnt lgkmcnt(0)
    v_mfma_f32_32x32x16_bf16 v[92:107], v[12:15], v[4:7], v[44:59]
    s_add_u32 m0, s66, 2048
    s_add_u32 s13, s67, 1056768
    buffer_load_dwordx4 v125, s[44:47], s13 offen lds
    s_add_u32 m0, s66, 3072
    s_add_u32 s13, s67, 1232896
    buffer_load_dwordx4 v125, s[44:47], s13 offen lds
    v_exp_f32 v113, v113
    v_exp_f32 v114, v114
    v_exp_f32 v115, v115
    v_exp_f32 v116, v116
    v_exp_f32 v117, v117
    v_smfmac_f32_32x32x32_bf16 v[76:91], v[28:31], v[108:115], v43
    v_exp_f32 v118, v118
    v_exp_f32 v119, v119
    v_exp_f32 v120, v120
    v_exp_f32 v121, v121
    v_exp_f32 v122, v122
    v_exp_f32 v123, v123
    v_exp_f32 v92, v92
    v_exp_f32 v93, v93
    v_smfmac_f32_32x32x32_bf16 v[76:91], v[32:35], v[116:123], v43
    s_mov_b64 exec, s[60:61]
    ds_read_b128 v[28:31], v2 offset:11264
    ds_read_b128 v[32:35], v2 offset:11008
    s_mov_b64 exec, -1
    s_add_u32 m0, s10, 32768
    s_add_u32 s13, s11, 32768
    buffer_load_dwordx4 v3, s[52:55], s13 offen sc1 lds
    buffer_load_dword v127, v3, s[52:55], s100 offen offset:0 sc1
    v_exp_f32 v94, v94
    v_exp_f32 v95, v95
    v_exp_f32 v96, v96
    v_mfma_f32_32x32x16_bf16 v[108:123], v[12:15], v[8:11], v[44:59]
    ds_read_b128 v[16:19], v2 offset:10240
    v_exp_f32 v97, v97
    v_exp_f32 v98, v98
    v_exp_f32 v99, v99
    v_exp_f32 v100, v100
    v_exp_f32 v101, v101
    v_smfmac_f32_32x32x32_bf16 v[60:75], v[20:23], v[92:99], v43
    v_exp_f32 v102, v102
    v_exp_f32 v103, v103
    v_exp_f32 v104, v104
    v_exp_f32 v105, v105
    v_exp_f32 v106, v106
    v_exp_f32 v107, v107
    v_exp_f32 v108, v108
    v_exp_f32 v109, v109
    v_smfmac_f32_32x32x32_bf16 v[60:75], v[24:27], v[100:107], v43
    v_exp_f32 v110, v110
    v_exp_f32 v111, v111
    v_exp_f32 v112, v112
    s_waitcnt lgkmcnt(0)
    v_mfma_f32_32x32x16_bf16 v[92:107], v[16:19], v[4:7], v[44:59]
    v_exp_f32 v113, v113
    v_exp_f32 v114, v114
    v_exp_f32 v115, v115
    v_exp_f32 v116, v116
    v_exp_f32 v117, v117
    v_smfmac_f32_32x32x32_bf16 v[76:91], v[20:23], v[108:115], v43
    v_exp_f32 v118, v118
    v_exp_f32 v119, v119
    v_exp_f32 v120, v120
    v_exp_f32 v121, v121
    v_exp_f32 v122, v122
    v_exp_f32 v123, v123
    v_exp_f32 v92, v92
    v_exp_f32 v93, v93
    v_smfmac_f32_32x32x32_bf16 v[76:91], v[24:27], v[116:123], v43
    s_mov_b64 exec, s[60:61]
    ds_read_b128 v[20:23], v2 offset:13312
    ds_read_b128 v[24:27], v2 offset:13056
    s_mov_b64 exec, -1
    s_add_u32 m0, s10, 98304
    s_add_u32 s13, s11, 98304
    buffer_load_dwordx4 v3, s[52:55], s13 offen sc1 lds
    v_exp_f32 v94, v94
    v_exp_f32 v95, v95
    v_exp_f32 v96, v96
    v_mfma_f32_32x32x16_bf16 v[108:123], v[16:19], v[8:11], v[44:59]
    ds_read_b128 v[12:15], v2 offset:12288
    s_waitcnt vmcnt(11)
    ds_read_b64_tr_b16 v[128:129], v41 offset:49152
    ds_read_b64_tr_b16 v[130:131], v41 offset:49408
    ds_read_b64_tr_b16 v[132:133], v42 offset:49152
    ds_read_b64_tr_b16 v[134:135], v42 offset:49408
    v_exp_f32 v97, v97
    v_exp_f32 v98, v98
    v_exp_f32 v99, v99
    v_exp_f32 v100, v100
    v_exp_f32 v101, v101
    v_smfmac_f32_32x32x32_bf16 v[60:75], v[28:31], v[92:99], v43
    v_exp_f32 v102, v102
    v_exp_f32 v103, v103
    v_exp_f32 v104, v104
    v_exp_f32 v105, v105
    v_exp_f32 v106, v106
    v_exp_f32 v107, v107
    v_exp_f32 v108, v108
    v_exp_f32 v109, v109
    v_smfmac_f32_32x32x32_bf16 v[60:75], v[32:35], v[100:107], v43
    v_exp_f32 v110, v110
    v_exp_f32 v111, v111
    v_exp_f32 v112, v112
    s_waitcnt lgkmcnt(0)
    v_mfma_f32_32x32x16_bf16 v[92:107], v[12:15], v[4:7], v[44:59]
    s_add_u32 m0, s10, 49152
    s_add_u32 s13, s67, 44032
    buffer_load_dwordx4 v125, s[44:47], s13 offen lds
    s_add_u32 m0, s10, 114688
    s_add_u32 s13, s67, 220160
    buffer_load_dwordx4 v125, s[44:47], s13 offen lds
    v_exp_f32 v113, v113
    v_exp_f32 v114, v114
    v_exp_f32 v115, v115
    v_exp_f32 v116, v116
    v_exp_f32 v117, v117
    v_smfmac_f32_32x32x32_bf16 v[76:91], v[28:31], v[108:115], v43
    v_exp_f32 v118, v118
    v_exp_f32 v119, v119
    v_exp_f32 v120, v120
    v_exp_f32 v121, v121
    v_exp_f32 v122, v122
    v_exp_f32 v123, v123
    v_exp_f32 v92, v92
    v_exp_f32 v93, v93
    v_smfmac_f32_32x32x32_bf16 v[76:91], v[32:35], v[116:123], v43
    s_mov_b64 exec, s[60:61]
    ds_read_b128 v[28:31], v2 offset:15360
    ds_read_b128 v[32:35], v2 offset:15104
    s_mov_b64 exec, -1
    s_add_u32 m0, s10, 40960
    s_add_u32 s13, s11, 40960
    buffer_load_dwordx4 v3, s[52:55], s13 offen sc1 lds
    v_exp_f32 v94, v94
    v_exp_f32 v95, v95
    v_exp_f32 v96, v96
    v_mfma_f32_32x32x16_bf16 v[108:123], v[12:15], v[8:11], v[44:59]
    ds_read_b128 v[16:19], v2 offset:14336
    s_waitcnt vmcnt(10)
    ds_read_b64_tr_b16 v[136:137], v41 offset:57344
    ds_read_b64_tr_b16 v[138:139], v41 offset:57600
    ds_read_b64_tr_b16 v[140:141], v42 offset:57344
    ds_read_b64_tr_b16 v[142:143], v42 offset:57600
    v_exp_f32 v97, v97
    v_exp_f32 v98, v98
    v_exp_f32 v99, v99
    v_exp_f32 v100, v100
    v_exp_f32 v101, v101
    v_smfmac_f32_32x32x32_bf16 v[60:75], v[20:23], v[92:99], v43
    v_exp_f32 v102, v102
    v_exp_f32 v103, v103
    v_exp_f32 v104, v104
    v_exp_f32 v105, v105
    v_exp_f32 v106, v106
    v_exp_f32 v107, v107
    v_exp_f32 v108, v108
    v_exp_f32 v109, v109
    v_smfmac_f32_32x32x32_bf16 v[60:75], v[24:27], v[100:107], v43
    v_exp_f32 v110, v110
    v_exp_f32 v111, v111
    v_exp_f32 v112, v112
    s_waitcnt lgkmcnt(0)
    v_mfma_f32_32x32x16_bf16 v[92:107], v[16:19], v[4:7], v[44:59]
    s_add_u32 m0, s10, 57344
    s_add_u32 s13, s67, 396288
    buffer_load_dwordx4 v125, s[44:47], s13 offen lds
    s_add_u32 m0, s10, 122880
    s_add_u32 s13, s67, 572416
    buffer_load_dwordx4 v125, s[44:47], s13 offen lds
    v_exp_f32 v113, v113
    v_exp_f32 v114, v114
    v_exp_f32 v115, v115
    v_exp_f32 v116, v116
    v_exp_f32 v117, v117
    v_smfmac_f32_32x32x32_bf16 v[76:91], v[20:23], v[108:115], v43
    v_exp_f32 v118, v118
    v_exp_f32 v119, v119
    v_exp_f32 v120, v120
    v_exp_f32 v121, v121
    v_exp_f32 v122, v122
    v_exp_f32 v123, v123
    v_exp_f32 v92, v92
    v_exp_f32 v93, v93
    v_smfmac_f32_32x32x32_bf16 v[76:91], v[24:27], v[116:123], v43
    s_mov_b64 exec, s[60:61]
    ds_read_b128 v[20:23], v2 offset:17408
    ds_read_b128 v[24:27], v2 offset:17152
    s_mov_b64 exec, -1
    s_add_u32 m0, s10, 106496
    s_add_u32 s13, s11, 106496
    buffer_load_dwordx4 v3, s[52:55], s13 offen sc1 lds
    v_exp_f32 v94, v94
    v_exp_f32 v95, v95
    v_exp_f32 v96, v96
    v_mfma_f32_32x32x16_bf16 v[108:123], v[16:19], v[8:11], v[44:59]
    ds_read_b128 v[12:15], v2 offset:16384
    s_waitcnt vmcnt(11)
    ds_read_b64_tr_b16 v[144:145], v124 offset:0
    ds_read_b64_tr_b16 v[146:147], v124 offset:256
    ds_read_b64_tr_b16 v[148:149], v124 offset:1024
    ds_read_b64_tr_b16 v[150:151], v124 offset:1280
    v_exp_f32 v97, v97
    v_exp_f32 v98, v98
    v_exp_f32 v99, v99
    v_exp_f32 v100, v100
    v_exp_f32 v101, v101
    v_smfmac_f32_32x32x32_bf16 v[60:75], v[28:31], v[92:99], v43
    v_exp_f32 v102, v102
    v_exp_f32 v103, v103
    v_exp_f32 v104, v104
    v_exp_f32 v105, v105
    v_exp_f32 v106, v106
    v_exp_f32 v107, v107
    v_exp_f32 v108, v108
    v_exp_f32 v109, v109
    v_smfmac_f32_32x32x32_bf16 v[60:75], v[32:35], v[100:107], v43
    v_exp_f32 v110, v110
    v_exp_f32 v111, v111
    v_exp_f32 v112, v112
    s_waitcnt lgkmcnt(0)
    v_mfma_f32_32x32x16_bf16 v[92:107], v[12:15], v[4:7], v[44:59]
    s_add_u32 m0, s66, 0
    s_add_u32 s13, s67, 748544
    buffer_load_dwordx4 v125, s[44:47], s13 offen lds
    s_add_u32 m0, s66, 1024
    s_add_u32 s13, s67, 924672
    buffer_load_dwordx4 v125, s[44:47], s13 offen lds
    v_exp_f32 v113, v113
    v_exp_f32 v114, v114
    v_exp_f32 v115, v115
    v_exp_f32 v116, v116
    v_exp_f32 v117, v117
    v_smfmac_f32_32x32x32_bf16 v[76:91], v[28:31], v[108:115], v43
    v_exp_f32 v118, v118
    v_exp_f32 v119, v119
    v_exp_f32 v120, v120
    v_exp_f32 v121, v121
    v_exp_f32 v122, v122
    v_exp_f32 v123, v123
    v_exp_f32 v92, v92
    v_exp_f32 v93, v93
    v_smfmac_f32_32x32x32_bf16 v[76:91], v[32:35], v[116:123], v43
    s_mov_b64 exec, s[60:61]
    ds_read_b128 v[28:31], v2 offset:19456
    ds_read_b128 v[32:35], v2 offset:19200
    s_mov_b64 exec, -1
    v_exp_f32 v94, v94
    v_exp_f32 v95, v95
    v_exp_f32 v96, v96
    v_mfma_f32_32x32x16_bf16 v[108:123], v[12:15], v[8:11], v[44:59]
    ds_read_b128 v[16:19], v2 offset:18432
    s_waitcnt vmcnt(11)
    ds_read_b64_tr_b16 v[152:153], v124 offset:2048
    ds_read_b64_tr_b16 v[154:155], v124 offset:2304
    ds_read_b64_tr_b16 v[156:157], v124 offset:3072
    ds_read_b64_tr_b16 v[158:159], v124 offset:3328
    v_exp_f32 v97, v97
    v_exp_f32 v98, v98
    v_exp_f32 v99, v99
    v_exp_f32 v100, v100
    v_exp_f32 v101, v101
    v_smfmac_f32_32x32x32_bf16 v[60:75], v[20:23], v[92:99], v43
    v_exp_f32 v102, v102
    v_exp_f32 v103, v103
    v_exp_f32 v104, v104
    v_exp_f32 v105, v105
    v_exp_f32 v106, v106
    v_exp_f32 v107, v107
    v_exp_f32 v108, v108
    v_exp_f32 v109, v109
    v_smfmac_f32_32x32x32_bf16 v[60:75], v[24:27], v[100:107], v43
    v_exp_f32 v110, v110
    v_exp_f32 v111, v111
    v_exp_f32 v112, v112
    s_waitcnt lgkmcnt(0)
    v_mfma_f32_32x32x16_bf16 v[92:107], v[16:19], v[4:7], v[44:59]
    s_add_u32 m0, s66, 2048
    s_add_u32 s13, s67, 1100800
    buffer_load_dwordx4 v125, s[44:47], s13 offen lds
    s_add_u32 m0, s66, 3072
    s_add_u32 s13, s67, 1276928
    buffer_load_dwordx4 v125, s[44:47], s13 offen lds
    v_exp_f32 v113, v113
    v_exp_f32 v114, v114
    v_exp_f32 v115, v115
    v_exp_f32 v116, v116
    v_exp_f32 v117, v117
    v_smfmac_f32_32x32x32_bf16 v[76:91], v[20:23], v[108:115], v43
    v_exp_f32 v118, v118
    v_exp_f32 v119, v119
    v_exp_f32 v120, v120
    v_exp_f32 v121, v121
    v_exp_f32 v122, v122
    v_exp_f32 v123, v123
    s_setprio 2
    v_exp_f32 v92, v92
    v_exp_f32 v93, v93
    v_smfmac_f32_32x32x32_bf16 v[76:91], v[24:27], v[116:123], v43
    s_mov_b64 exec, s[60:61]
    ds_read_b128 v[20:23], v2 offset:21504
    ds_read_b128 v[24:27], v2 offset:21248
    s_mov_b64 exec, -1
    buffer_load_dword v127, v3, s[52:55], s63 offen offset:0 sc1
    buffer_load_dword v127, v3, s[52:55], s101 offen offset:0 sc1
    v_exp_f32 v94, v94
    v_exp_f32 v95, v95
    v_exp_f32 v96, v96
    v_mfma_f32_32x32x16_bf16 v[108:123], v[16:19], v[8:11], v[44:59]
    ds_read_b128 v[12:15], v2 offset:20480
    v_exp_f32 v97, v97
    v_exp_f32 v98, v98
    v_exp_f32 v99, v99
    v_exp_f32 v100, v100
    v_exp_f32 v101, v101
    v_smfmac_f32_32x32x32_bf16 v[60:75], v[28:31], v[92:99], v43
    v_exp_f32 v102, v102
    v_exp_f32 v103, v103
    v_exp_f32 v104, v104
    v_exp_f32 v105, v105
    v_exp_f32 v106, v106
    v_exp_f32 v107, v107
    v_exp_f32 v108, v108
    v_exp_f32 v109, v109
    v_smfmac_f32_32x32x32_bf16 v[60:75], v[32:35], v[100:107], v43
    v_exp_f32 v110, v110
    v_exp_f32 v111, v111
    v_exp_f32 v112, v112
    s_waitcnt lgkmcnt(0)
    v_mfma_f32_32x32x16_bf16 v[92:107], v[12:15], v[4:7], v[44:59]
    v_exp_f32 v113, v113
    v_exp_f32 v114, v114
    v_exp_f32 v115, v115
    v_exp_f32 v116, v116
    v_exp_f32 v117, v117
    v_smfmac_f32_32x32x32_bf16 v[76:91], v[28:31], v[108:115], v43
    v_exp_f32 v118, v118
    v_exp_f32 v119, v119
    v_exp_f32 v120, v120
    v_exp_f32 v121, v121
    v_exp_f32 v122, v122
    v_exp_f32 v123, v123
    v_exp_f32 v92, v92
    v_exp_f32 v93, v93
    v_smfmac_f32_32x32x32_bf16 v[76:91], v[32:35], v[116:123], v43
    s_mov_b64 exec, s[60:61]
    ds_read_b128 v[28:31], v2 offset:23552
    ds_read_b128 v[32:35], v2 offset:23296
    s_mov_b64 exec, -1
    v_exp_f32 v94, v94
    v_exp_f32 v95, v95
    v_exp_f32 v96, v96
    v_mfma_f32_32x32x16_bf16 v[108:123], v[12:15], v[8:11], v[44:59]
    ds_read_b128 v[16:19], v2 offset:22528
    s_waitcnt vmcnt(10)
    ds_read_b64_tr_b16 v[160:161], v41 offset:49152
    ds_read_b64_tr_b16 v[162:163], v41 offset:49408
    ds_read_b64_tr_b16 v[164:165], v42 offset:49152
    ds_read_b64_tr_b16 v[166:167], v42 offset:49408
    v_exp_f32 v97, v97
    v_exp_f32 v98, v98
    v_exp_f32 v99, v99
    v_exp_f32 v100, v100
    v_exp_f32 v101, v101
    v_smfmac_f32_32x32x32_bf16 v[60:75], v[20:23], v[92:99], v43
    v_exp_f32 v102, v102
    v_exp_f32 v103, v103
    v_exp_f32 v104, v104
    v_exp_f32 v105, v105
    v_exp_f32 v106, v106
    v_exp_f32 v107, v107
    v_exp_f32 v108, v108
    v_exp_f32 v109, v109
    v_smfmac_f32_32x32x32_bf16 v[60:75], v[24:27], v[100:107], v43
    v_exp_f32 v110, v110
    v_exp_f32 v111, v111
    v_exp_f32 v112, v112
    s_waitcnt lgkmcnt(0)
    v_mfma_f32_32x32x16_bf16 v[92:107], v[16:19], v[4:7], v[44:59]
    s_add_u32 m0, s10, 49152
    s_add_u32 s13, s11, 49152
    buffer_load_dwordx4 v3, s[52:55], s13 offen sc1 lds
    s_add_u32 m0, s10, 114688
    s_add_u32 s13, s11, 114688
    buffer_load_dwordx4 v3, s[52:55], s13 offen sc1 lds
    v_exp_f32 v113, v113
    v_exp_f32 v114, v114
    v_exp_f32 v115, v115
    v_exp_f32 v116, v116
    v_exp_f32 v117, v117
    v_smfmac_f32_32x32x32_bf16 v[76:91], v[20:23], v[108:115], v43
    v_exp_f32 v118, v118
    v_exp_f32 v119, v119
    v_exp_f32 v120, v120
    v_exp_f32 v121, v121
    v_exp_f32 v122, v122
    v_exp_f32 v123, v123
    v_exp_f32 v92, v92
    v_exp_f32 v93, v93
    v_smfmac_f32_32x32x32_bf16 v[76:91], v[24:27], v[116:123], v43
    s_mov_b64 exec, s[60:61]
    ds_read_b128 v[20:23], v2 offset:25600
    ds_read_b128 v[24:27], v2 offset:25344
    s_mov_b64 exec, -1
    v_exp_f32 v94, v94
    v_exp_f32 v95, v95
    v_exp_f32 v96, v96
    v_mfma_f32_32x32x16_bf16 v[108:123], v[16:19], v[8:11], v[44:59]
    ds_read_b128 v[12:15], v2 offset:24576
    s_waitcnt vmcnt(9)
    ds_read_b64_tr_b16 v[168:169], v41 offset:57344
    ds_read_b64_tr_b16 v[170:171], v41 offset:57600
    ds_read_b64_tr_b16 v[172:173], v42 offset:57344
    ds_read_b64_tr_b16 v[174:175], v42 offset:57600
    v_exp_f32 v97, v97
    v_exp_f32 v98, v98
    v_exp_f32 v99, v99
    v_exp_f32 v100, v100
    v_exp_f32 v101, v101
    v_smfmac_f32_32x32x32_bf16 v[60:75], v[28:31], v[92:99], v43
    v_exp_f32 v102, v102
    v_exp_f32 v103, v103
    v_exp_f32 v104, v104
    v_exp_f32 v105, v105
    v_exp_f32 v106, v106
    v_exp_f32 v107, v107
    v_exp_f32 v108, v108
    v_exp_f32 v109, v109
    v_smfmac_f32_32x32x32_bf16 v[60:75], v[32:35], v[100:107], v43
    v_exp_f32 v110, v110
    v_exp_f32 v111, v111
    v_exp_f32 v112, v112
    s_waitcnt lgkmcnt(0)
    v_mfma_f32_32x32x16_bf16 v[92:107], v[12:15], v[4:7], v[44:59]
    s_add_u32 m0, s10, 57344
    s_add_u32 s13, s11, 57344
    buffer_load_dwordx4 v3, s[52:55], s13 offen sc1 lds
    s_add_u32 m0, s10, 122880
    s_add_u32 s13, s11, 122880
    buffer_load_dwordx4 v3, s[52:55], s13 offen sc1 lds
    v_exp_f32 v113, v113
    v_exp_f32 v114, v114
    v_exp_f32 v115, v115
    v_exp_f32 v116, v116
    v_exp_f32 v117, v117
    v_smfmac_f32_32x32x32_bf16 v[76:91], v[28:31], v[108:115], v43
    v_exp_f32 v118, v118
    v_exp_f32 v119, v119
    v_exp_f32 v120, v120
    v_exp_f32 v121, v121
    v_exp_f32 v122, v122
    v_exp_f32 v123, v123
    v_exp_f32 v92, v92
    v_exp_f32 v93, v93
    v_smfmac_f32_32x32x32_bf16 v[76:91], v[32:35], v[116:123], v43
    s_mov_b64 exec, s[60:61]
    ds_read_b128 v[28:31], v2 offset:27648
    ds_read_b128 v[32:35], v2 offset:27392
    s_mov_b64 exec, -1
    v_exp_f32 v94, v94
    v_exp_f32 v95, v95
    v_exp_f32 v96, v96
    v_mfma_f32_32x32x16_bf16 v[108:123], v[12:15], v[8:11], v[44:59]
    ds_read_b128 v[16:19], v2 offset:26624
    s_waitcnt vmcnt(8)
    ds_read_b64_tr_b16 v[176:177], v124 offset:0
    ds_read_b64_tr_b16 v[178:179], v124 offset:256
    ds_read_b64_tr_b16 v[180:181], v124 offset:1024
    ds_read_b64_tr_b16 v[182:183], v124 offset:1280
    v_exp_f32 v97, v97
    v_exp_f32 v98, v98
    v_exp_f32 v99, v99
    v_exp_f32 v100, v100
    v_exp_f32 v101, v101
    v_smfmac_f32_32x32x32_bf16 v[60:75], v[20:23], v[92:99], v43
    v_exp_f32 v102, v102
    v_exp_f32 v103, v103
    v_exp_f32 v104, v104
    v_exp_f32 v105, v105
    v_exp_f32 v106, v106
    v_exp_f32 v107, v107
    v_exp_f32 v108, v108
    v_exp_f32 v109, v109
    v_smfmac_f32_32x32x32_bf16 v[60:75], v[24:27], v[100:107], v43
    v_exp_f32 v110, v110
    v_exp_f32 v111, v111
    v_exp_f32 v112, v112
    s_waitcnt lgkmcnt(0)
    v_mfma_f32_32x32x16_bf16 v[92:107], v[16:19], v[4:7], v[44:59]
    s_add_u32 m0, s66, 0
    s_add_u32 s13, s67, 88064
    buffer_load_dwordx4 v125, s[44:47], s13 offen lds
    s_add_u32 m0, s66, 1024
    s_add_u32 s13, s67, 264192
    buffer_load_dwordx4 v125, s[44:47], s13 offen lds
    v_exp_f32 v113, v113
    v_exp_f32 v114, v114
    v_exp_f32 v115, v115
    v_exp_f32 v116, v116
    v_exp_f32 v117, v117
    v_smfmac_f32_32x32x32_bf16 v[76:91], v[20:23], v[108:115], v43
    v_exp_f32 v118, v118
    v_exp_f32 v119, v119
    v_exp_f32 v120, v120
    v_exp_f32 v121, v121
    v_exp_f32 v122, v122
    v_exp_f32 v123, v123
    s_setprio 1
    v_exp_f32 v92, v92
    v_exp_f32 v93, v93
    v_smfmac_f32_32x32x32_bf16 v[76:91], v[24:27], v[116:123], v43
    s_mov_b64 exec, s[60:61]
    ds_read_b128 v[20:23], v2 offset:29696
    ds_read_b128 v[24:27], v2 offset:29440
    s_mov_b64 exec, -1
    v_exp_f32 v94, v94
    v_exp_f32 v95, v95
    v_exp_f32 v96, v96
    v_mfma_f32_32x32x16_bf16 v[108:123], v[16:19], v[8:11], v[44:59]
    ds_read_b128 v[12:15], v2 offset:28672
    s_waitcnt vmcnt(8)
    ds_read_b64_tr_b16 v[184:185], v124 offset:2048
    ds_read_b64_tr_b16 v[186:187], v124 offset:2304
    ds_read_b64_tr_b16 v[188:189], v124 offset:3072
    ds_read_b64_tr_b16 v[190:191], v124 offset:3328
    v_exp_f32 v97, v97
    v_exp_f32 v98, v98
    v_exp_f32 v99, v99
    v_exp_f32 v100, v100
    v_exp_f32 v101, v101
    v_smfmac_f32_32x32x32_bf16 v[60:75], v[28:31], v[92:99], v43
    v_exp_f32 v102, v102
    v_exp_f32 v103, v103
    v_exp_f32 v104, v104
    v_exp_f32 v105, v105
    v_exp_f32 v106, v106
    v_exp_f32 v107, v107
    v_exp_f32 v108, v108
    v_exp_f32 v109, v109
    v_smfmac_f32_32x32x32_bf16 v[60:75], v[32:35], v[100:107], v43
    v_exp_f32 v110, v110
    v_exp_f32 v111, v111
    v_exp_f32 v112, v112
    s_waitcnt lgkmcnt(0)
    v_mfma_f32_32x32x16_bf16 v[92:107], v[12:15], v[4:7], v[44:59]
    s_add_u32 m0, s66, 2048
    s_add_u32 s13, s67, 440320
    buffer_load_dwordx4 v125, s[44:47], s13 offen lds
    s_add_u32 m0, s66, 3072
    s_add_u32 s13, s67, 616448
    buffer_load_dwordx4 v125, s[44:47], s13 offen lds
    v_exp_f32 v113, v113
    v_exp_f32 v114, v114
    v_exp_f32 v115, v115
    v_exp_f32 v116, v116
    v_exp_f32 v117, v117
    v_smfmac_f32_32x32x32_bf16 v[76:91], v[28:31], v[108:115], v43
    v_exp_f32 v118, v118
    v_exp_f32 v119, v119
    v_exp_f32 v120, v120
    v_exp_f32 v121, v121
    v_exp_f32 v122, v122
    v_exp_f32 v123, v123
    v_exp_f32 v92, v92
    v_exp_f32 v93, v93
    v_smfmac_f32_32x32x32_bf16 v[76:91], v[32:35], v[116:123], v43
    s_mov_b64 exec, s[60:61]
    ds_read_b128 v[28:31], v2 offset:31744
    ds_read_b128 v[32:35], v2 offset:31488
    s_mov_b64 exec, -1
    buffer_load_dword v127, v3, s[52:55], s101 offen offset:1024 sc1
    s_add_u32 s13, s62, 0
    s_and_b32 s14, s13, 7
    s_lshr_b32 s13, s13, 3
    s_lshl_b32 s13, s13, 14
    s_lshl_b32 s14, s14, 7
    s_add_u32 s13, s13, s14
    buffer_load_dword v127, v126, s[56:59], s13 offen
    v_exp_f32 v94, v94
    v_exp_f32 v95, v95
    v_exp_f32 v96, v96
    v_mfma_f32_32x32x16_bf16 v[108:123], v[12:15], v[8:11], v[44:59]
    ds_read_b128 v[16:19], v2 offset:30720
    v_exp_f32 v97, v97
    v_exp_f32 v98, v98
    v_exp_f32 v99, v99
    v_exp_f32 v100, v100
    v_exp_f32 v101, v101
    v_smfmac_f32_32x32x32_bf16 v[60:75], v[20:23], v[92:99], v43
    v_exp_f32 v102, v102
    v_exp_f32 v103, v103
    v_exp_f32 v104, v104
    v_exp_f32 v105, v105
    v_exp_f32 v106, v106
    v_exp_f32 v107, v107
    s_setprio 0
    v_exp_f32 v108, v108
    v_exp_f32 v109, v109
    v_smfmac_f32_32x32x32_bf16 v[60:75], v[24:27], v[100:107], v43
    v_exp_f32 v110, v110
    v_exp_f32 v111, v111
    v_exp_f32 v112, v112
    s_waitcnt lgkmcnt(0)
    v_mfma_f32_32x32x16_bf16 v[92:107], v[16:19], v[4:7], v[44:59]
    v_exp_f32 v113, v113
    v_exp_f32 v114, v114
    v_exp_f32 v115, v115
    v_exp_f32 v116, v116
    v_exp_f32 v117, v117
    v_smfmac_f32_32x32x32_bf16 v[76:91], v[20:23], v[108:115], v43
    v_exp_f32 v118, v118
    v_exp_f32 v119, v119
    v_exp_f32 v120, v120
    v_exp_f32 v121, v121
    v_exp_f32 v122, v122
    v_exp_f32 v123, v123
    s_waitcnt vmcnt(6)
    s_barrier
    s_setprio 3
    v_exp_f32 v92, v92
    v_exp_f32 v93, v93
    v_smfmac_f32_32x32x32_bf16 v[76:91], v[24:27], v[116:123], v43
    s_mov_b64 exec, s[60:61]
    ds_read_b128 v[20:23], v2 offset:33792
    ds_read_b128 v[24:27], v2 offset:33536
    s_mov_b64 exec, -1
    v_exp_f32 v94, v94
    v_exp_f32 v95, v95
    v_exp_f32 v96, v96
    v_mfma_f32_32x32x16_bf16 v[108:123], v[16:19], v[8:11], v[44:59]
    ds_read_b128 v[12:15], v2 offset:32768
    v_exp_f32 v97, v97
    v_exp_f32 v98, v98
    v_exp_f32 v99, v99
    v_exp_f32 v100, v100
    v_exp_f32 v101, v101
    v_smfmac_f32_32x32x32_bf16 v[60:75], v[28:31], v[92:99], v43
    v_exp_f32 v102, v102
    v_exp_f32 v103, v103
    v_exp_f32 v104, v104
    v_exp_f32 v105, v105
    v_exp_f32 v106, v106
    v_exp_f32 v107, v107
    v_exp_f32 v108, v108
    v_exp_f32 v109, v109
    v_smfmac_f32_32x32x32_bf16 v[60:75], v[32:35], v[100:107], v43
    v_exp_f32 v110, v110
    v_exp_f32 v111, v111
    v_exp_f32 v112, v112
    s_waitcnt lgkmcnt(0)
    v_mfma_f32_32x32x16_bf16 v[92:107], v[12:15], v[4:7], v[44:59]
    s_add_u32 m0, s10, 0
    s_add_u32 s13, s67, 792576
    buffer_load_dwordx4 v125, s[44:47], s13 offen lds
    s_add_u32 m0, s10, 16384
    s_add_u32 s13, s67, 968704
    buffer_load_dwordx4 v125, s[44:47], s13 offen lds
    v_exp_f32 v113, v113
    v_exp_f32 v114, v114
    v_exp_f32 v115, v115
    v_exp_f32 v116, v116
    v_exp_f32 v117, v117
    v_smfmac_f32_32x32x32_bf16 v[76:91], v[28:31], v[108:115], v43
    v_exp_f32 v118, v118
    v_exp_f32 v119, v119
    v_exp_f32 v120, v120
    v_exp_f32 v121, v121
    v_exp_f32 v122, v122
    v_exp_f32 v123, v123
    v_exp_f32 v92, v92
    v_exp_f32 v93, v93
    v_smfmac_f32_32x32x32_bf16 v[76:91], v[32:35], v[116:123], v43
    s_mov_b64 exec, s[60:61]
    ds_read_b128 v[28:31], v2 offset:35840
    ds_read_b128 v[32:35], v2 offset:35584
    s_mov_b64 exec, -1
    v_exp_f32 v94, v94
    v_exp_f32 v95, v95
    v_exp_f32 v96, v96
    v_mfma_f32_32x32x16_bf16 v[108:123], v[12:15], v[8:11], v[44:59]
    ds_read_b128 v[16:19], v2 offset:34816
    v_exp_f32 v97, v97
    v_exp_f32 v98, v98
    v_exp_f32 v99, v99
    v_exp_f32 v100, v100
    v_exp_f32 v101, v101
    v_smfmac_f32_32x32x32_bf16 v[60:75], v[20:23], v[92:99], v43
    v_exp_f32 v102, v102
    v_exp_f32 v103, v103
    v_exp_f32 v104, v104
    v_exp_f32 v105, v105
    v_exp_f32 v106, v106
    v_exp_f32 v107, v107
    v_exp_f32 v108, v108
    v_exp_f32 v109, v109
    v_smfmac_f32_32x32x32_bf16 v[60:75], v[24:27], v[100:107], v43
    v_exp_f32 v110, v110
    v_exp_f32 v111, v111
    v_exp_f32 v112, v112
    s_waitcnt lgkmcnt(0)
    v_mfma_f32_32x32x16_bf16 v[92:107], v[16:19], v[4:7], v[44:59]
    s_add_u32 m0, s10, 8192
    s_add_u32 s13, s67, 1144832
    buffer_load_dwordx4 v125, s[44:47], s13 offen lds
    s_add_u32 m0, s10, 24576
    s_add_u32 s13, s67, 1320960
    buffer_load_dwordx4 v125, s[44:47], s13 offen lds
    v_exp_f32 v113, v113
    v_exp_f32 v114, v114
    v_exp_f32 v115, v115
    v_exp_f32 v116, v116
    v_exp_f32 v117, v117
    v_smfmac_f32_32x32x32_bf16 v[76:91], v[20:23], v[108:115], v43
    v_exp_f32 v118, v118
    v_exp_f32 v119, v119
    v_exp_f32 v120, v120
    v_exp_f32 v121, v121
    v_exp_f32 v122, v122
    v_exp_f32 v123, v123
    v_exp_f32 v92, v92
    v_exp_f32 v93, v93
    v_smfmac_f32_32x32x32_bf16 v[76:91], v[24:27], v[116:123], v43
    s_mov_b64 exec, s[60:61]
    ds_read_b128 v[20:23], v2 offset:37888
    ds_read_b128 v[24:27], v2 offset:37632
    s_mov_b64 exec, -1
    v_exp_f32 v94, v94
    v_exp_f32 v95, v95
    v_exp_f32 v96, v96
    v_mfma_f32_32x32x16_bf16 v[108:123], v[16:19], v[8:11], v[44:59]
    ds_read_b128 v[12:15], v2 offset:36864
    s_waitcnt vmcnt(8)
    ds_read_b64_tr_b16 v[192:193], v124 offset:0
    ds_read_b64_tr_b16 v[194:195], v124 offset:256
    ds_read_b64_tr_b16 v[196:197], v124 offset:1024
    ds_read_b64_tr_b16 v[198:199], v124 offset:1280
    v_exp_f32 v97, v97
    v_exp_f32 v98, v98
    v_exp_f32 v99, v99
    v_exp_f32 v100, v100
    v_exp_f32 v101, v101
    v_smfmac_f32_32x32x32_bf16 v[60:75], v[28:31], v[92:99], v43
    v_exp_f32 v102, v102
    v_exp_f32 v103, v103
    v_exp_f32 v104, v104
    v_exp_f32 v105, v105
    v_exp_f32 v106, v106
    v_exp_f32 v107, v107
    v_exp_f32 v108, v108
    v_exp_f32 v109, v109
    v_smfmac_f32_32x32x32_bf16 v[60:75], v[32:35], v[100:107], v43
    v_exp_f32 v110, v110
    v_exp_f32 v111, v111
    v_exp_f32 v112, v112
    s_waitcnt lgkmcnt(0)
    v_mfma_f32_32x32x16_bf16 v[92:107], v[12:15], v[4:7], v[44:59]
    s_add_u32 m0, s10, 65536
    s_add_u32 s13, s67, 132096
    buffer_load_dwordx4 v125, s[44:47], s13 offen lds
    s_add_u32 m0, s10, 81920
    s_add_u32 s13, s67, 308224
    buffer_load_dwordx4 v125, s[44:47], s13 offen lds
    v_exp_f32 v113, v113
    v_exp_f32 v114, v114
    v_exp_f32 v115, v115
    v_exp_f32 v116, v116
    v_exp_f32 v117, v117
    v_smfmac_f32_32x32x32_bf16 v[76:91], v[28:31], v[108:115], v43
    v_exp_f32 v118, v118
    v_exp_f32 v119, v119
    v_exp_f32 v120, v120
    v_exp_f32 v121, v121
    v_exp_f32 v122, v122
    v_exp_f32 v123, v123
    v_exp_f32 v92, v92
    v_exp_f32 v93, v93
    v_smfmac_f32_32x32x32_bf16 v[76:91], v[32:35], v[116:123], v43
    s_mov_b64 exec, s[60:61]
    ds_read_b128 v[28:31], v2 offset:39936
    ds_read_b128 v[32:35], v2 offset:39680
    s_mov_b64 exec, -1
    v_exp_f32 v94, v94
    v_exp_f32 v95, v95
    v_exp_f32 v96, v96
    v_mfma_f32_32x32x16_bf16 v[108:123], v[12:15], v[8:11], v[44:59]
    ds_read_b128 v[16:19], v2 offset:38912
    s_waitcnt vmcnt(8)
    ds_read_b64_tr_b16 v[200:201], v124 offset:2048
    ds_read_b64_tr_b16 v[202:203], v124 offset:2304
    ds_read_b64_tr_b16 v[204:205], v124 offset:3072
    ds_read_b64_tr_b16 v[206:207], v124 offset:3328
    v_exp_f32 v97, v97
    v_exp_f32 v98, v98
    v_exp_f32 v99, v99
    v_exp_f32 v100, v100
    v_exp_f32 v101, v101
    v_smfmac_f32_32x32x32_bf16 v[60:75], v[20:23], v[92:99], v43
    v_exp_f32 v102, v102
    v_exp_f32 v103, v103
    v_exp_f32 v104, v104
    v_exp_f32 v105, v105
    v_exp_f32 v106, v106
    v_exp_f32 v107, v107
    v_exp_f32 v108, v108
    v_exp_f32 v109, v109
    v_smfmac_f32_32x32x32_bf16 v[60:75], v[24:27], v[100:107], v43
    v_exp_f32 v110, v110
    v_exp_f32 v111, v111
    v_exp_f32 v112, v112
    s_waitcnt lgkmcnt(0)
    v_mfma_f32_32x32x16_bf16 v[92:107], v[16:19], v[4:7], v[44:59]
    s_add_u32 m0, s10, 73728
    s_add_u32 s13, s67, 484352
    buffer_load_dwordx4 v125, s[44:47], s13 offen lds
    s_add_u32 m0, s10, 90112
    s_add_u32 s13, s67, 660480
    buffer_load_dwordx4 v125, s[44:47], s13 offen lds
    v_exp_f32 v113, v113
    v_exp_f32 v114, v114
    v_exp_f32 v115, v115
    v_exp_f32 v116, v116
    v_exp_f32 v117, v117
    v_smfmac_f32_32x32x32_bf16 v[76:91], v[20:23], v[108:115], v43
    v_exp_f32 v118, v118
    v_exp_f32 v119, v119
    v_exp_f32 v120, v120
    v_exp_f32 v121, v121
    v_exp_f32 v122, v122
    v_exp_f32 v123, v123
    v_exp_f32 v92, v92
    v_exp_f32 v93, v93
    v_smfmac_f32_32x32x32_bf16 v[76:91], v[24:27], v[116:123], v43
    s_mov_b64 exec, s[60:61]
    ds_read_b128 v[20:23], v2 offset:41984
    ds_read_b128 v[24:27], v2 offset:41728
    s_mov_b64 exec, -1
    v_exp_f32 v94, v94
    v_exp_f32 v95, v95
    v_exp_f32 v96, v96
    v_mfma_f32_32x32x16_bf16 v[108:123], v[16:19], v[8:11], v[44:59]
    ds_read_b128 v[12:15], v2 offset:40960
    v_exp_f32 v97, v97
    v_exp_f32 v98, v98
    v_exp_f32 v99, v99
    v_exp_f32 v100, v100
    v_exp_f32 v101, v101
    v_smfmac_f32_32x32x32_bf16 v[60:75], v[28:31], v[92:99], v43
    v_exp_f32 v102, v102
    v_exp_f32 v103, v103
    v_exp_f32 v104, v104
    v_exp_f32 v105, v105
    v_exp_f32 v106, v106
    v_exp_f32 v107, v107
    v_exp_f32 v108, v108
    v_exp_f32 v109, v109
    v_smfmac_f32_32x32x32_bf16 v[60:75], v[32:35], v[100:107], v43
    v_exp_f32 v110, v110
    v_exp_f32 v111, v111
    v_exp_f32 v112, v112
    s_waitcnt lgkmcnt(0)
    v_mfma_f32_32x32x16_bf16 v[92:107], v[12:15], v[4:7], v[44:59]
    s_add_u32 m0, s66, 0
    s_add_u32 s13, s67, 836608
    buffer_load_dwordx4 v125, s[44:47], s13 offen lds
    s_add_u32 m0, s66, 1024
    s_add_u32 s13, s67, 1012736
    buffer_load_dwordx4 v125, s[44:47], s13 offen lds
    v_exp_f32 v113, v113
    v_exp_f32 v114, v114
    v_exp_f32 v115, v115
    v_exp_f32 v116, v116
    v_exp_f32 v117, v117
    v_smfmac_f32_32x32x32_bf16 v[76:91], v[28:31], v[108:115], v43
    v_exp_f32 v118, v118
    v_exp_f32 v119, v119
    v_exp_f32 v120, v120
    v_exp_f32 v121, v121
    v_exp_f32 v122, v122
    v_exp_f32 v123, v123
    v_exp_f32 v92, v92
    v_exp_f32 v93, v93
    v_smfmac_f32_32x32x32_bf16 v[76:91], v[32:35], v[116:123], v43
    s_mov_b64 exec, s[60:61]
    ds_read_b128 v[28:31], v2 offset:44032
    ds_read_b128 v[32:35], v2 offset:43776
    s_mov_b64 exec, -1
    v_exp_f32 v94, v94
    v_exp_f32 v95, v95
    v_exp_f32 v96, v96
    v_mfma_f32_32x32x16_bf16 v[108:123], v[12:15], v[8:11], v[44:59]
    ds_read_b128 v[16:19], v2 offset:43008
    s_waitcnt vmcnt(8)
    ds_read_b64_tr_b16 v[208:209], v41 offset:0
    ds_read_b64_tr_b16 v[210:211], v41 offset:256
    ds_read_b64_tr_b16 v[212:213], v41 offset:16384
    ds_read_b64_tr_b16 v[214:215], v41 offset:16640
    v_exp_f32 v97, v97
    v_exp_f32 v98, v98
    v_exp_f32 v99, v99
    v_exp_f32 v100, v100
    v_exp_f32 v101, v101
    v_smfmac_f32_32x32x32_bf16 v[60:75], v[20:23], v[92:99], v43
    v_exp_f32 v102, v102
    v_exp_f32 v103, v103
    v_exp_f32 v104, v104
    v_exp_f32 v105, v105
    v_exp_f32 v106, v106
    v_exp_f32 v107, v107
    v_exp_f32 v108, v108
    v_exp_f32 v109, v109
    v_smfmac_f32_32x32x32_bf16 v[60:75], v[24:27], v[100:107], v43
    v_exp_f32 v110, v110
    v_exp_f32 v111, v111
    v_exp_f32 v112, v112
    s_waitcnt lgkmcnt(0)
    v_mfma_f32_32x32x16_bf16 v[92:107], v[16:19], v[4:7], v[44:59]
    s_add_u32 m0, s10, 0
    s_add_u32 s13, s67, 1188864
    buffer_load_dwordx4 v125, s[44:47], s13 offen lds
    s_add_u32 m0, s10, 16384
    s_add_u32 s13, s67, 1364992
    buffer_load_dwordx4 v125, s[44:47], s13 offen lds
    v_exp_f32 v113, v113
    v_exp_f32 v114, v114
    v_exp_f32 v115, v115
    v_exp_f32 v116, v116
    v_exp_f32 v117, v117
    v_smfmac_f32_32x32x32_bf16 v[76:91], v[20:23], v[108:115], v43
    v_exp_f32 v118, v118
    v_exp_f32 v119, v119
    v_exp_f32 v120, v120
    v_exp_f32 v121, v121
    v_exp_f32 v122, v122
    v_exp_f32 v123, v123
    v_exp_f32 v92, v92
    v_exp_f32 v93, v93
    v_smfmac_f32_32x32x32_bf16 v[76:91], v[24:27], v[116:123], v43
    s_mov_b64 exec, s[60:61]
    ds_read_b128 v[20:23], v2 offset:46080
    ds_read_b128 v[24:27], v2 offset:45824
    s_mov_b64 exec, -1
    v_exp_f32 v94, v94
    v_exp_f32 v95, v95
    v_exp_f32 v96, v96
    v_mfma_f32_32x32x16_bf16 v[108:123], v[16:19], v[8:11], v[44:59]
    ds_read_b128 v[12:15], v2 offset:45056
    s_waitcnt vmcnt(8)
    ds_read_b64_tr_b16 v[216:217], v41 offset:8192
    ds_read_b64_tr_b16 v[218:219], v41 offset:8448
    ds_read_b64_tr_b16 v[220:221], v41 offset:24576
    ds_read_b64_tr_b16 v[222:223], v41 offset:24832
    v_exp_f32 v97, v97
    v_exp_f32 v98, v98
    v_exp_f32 v99, v99
    v_exp_f32 v100, v100
    v_exp_f32 v101, v101
    v_smfmac_f32_32x32x32_bf16 v[60:75], v[28:31], v[92:99], v43
    v_exp_f32 v102, v102
    v_exp_f32 v103, v103
    v_exp_f32 v104, v104
    v_exp_f32 v105, v105
    v_exp_f32 v106, v106
    v_exp_f32 v107, v107
    v_exp_f32 v108, v108
    v_exp_f32 v109, v109
    v_smfmac_f32_32x32x32_bf16 v[60:75], v[32:35], v[100:107], v43
    v_exp_f32 v110, v110
    v_exp_f32 v111, v111
    v_exp_f32 v112, v112
    s_waitcnt lgkmcnt(0)
    v_mfma_f32_32x32x16_bf16 v[92:107], v[12:15], v[4:7], v[44:59]
    s_add_u32 m0, s10, 8192
    s_add_u32 s13, s69, 131072
    buffer_load_dwordx4 v126, s[48:51], s13 offen lds
    s_add_u32 m0, s10, 24576
    s_add_u32 s13, s69, 131136
    buffer_load_dwordx4 v126, s[48:51], s13 offen lds
    v_exp_f32 v113, v113
    v_exp_f32 v114, v114
    v_exp_f32 v115, v115
    v_exp_f32 v116, v116
    v_exp_f32 v117, v117
    v_smfmac_f32_32x32x32_bf16 v[76:91], v[28:31], v[108:115], v43
    v_exp_f32 v118, v118
    v_exp_f32 v119, v119
    v_exp_f32 v120, v120
    v_exp_f32 v121, v121
    v_exp_f32 v122, v122
    v_exp_f32 v123, v123
    v_exp_f32 v92, v92
    v_exp_f32 v93, v93
    v_smfmac_f32_32x32x32_bf16 v[76:91], v[32:35], v[116:123], v43
    s_mov_b64 exec, s[60:61]
    ds_read_b128 v[28:31], v2 offset:48128
    ds_read_b128 v[32:35], v2 offset:47872
    s_mov_b64 exec, -1
    v_exp_f32 v94, v94
    v_exp_f32 v95, v95
    v_exp_f32 v96, v96
    v_mfma_f32_32x32x16_bf16 v[108:123], v[12:15], v[8:11], v[44:59]
    ds_read_b128 v[16:19], v2 offset:47104
    s_waitcnt vmcnt(8)
    ds_read_b64_tr_b16 v[224:225], v42 offset:0
    ds_read_b64_tr_b16 v[226:227], v42 offset:256
    ds_read_b64_tr_b16 v[228:229], v42 offset:16384
    ds_read_b64_tr_b16 v[230:231], v42 offset:16640
    v_exp_f32 v97, v97
    v_exp_f32 v98, v98
    v_exp_f32 v99, v99
    v_exp_f32 v100, v100
    v_exp_f32 v101, v101
    v_smfmac_f32_32x32x32_bf16 v[60:75], v[20:23], v[92:99], v43
    v_exp_f32 v102, v102
    v_exp_f32 v103, v103
    v_exp_f32 v104, v104
    v_exp_f32 v105, v105
    v_exp_f32 v106, v106
    v_exp_f32 v107, v107
    v_exp_f32 v108, v108
    v_exp_f32 v109, v109
    v_smfmac_f32_32x32x32_bf16 v[60:75], v[24:27], v[100:107], v43
    v_exp_f32 v110, v110
    v_exp_f32 v111, v111
    v_exp_f32 v112, v112
    s_waitcnt lgkmcnt(0)
    v_mfma_f32_32x32x16_bf16 v[92:107], v[16:19], v[4:7], v[44:59]
    s_add_u32 m0, s10, 65536
    s_add_u32 s13, s69, 262144
    buffer_load_dwordx4 v126, s[48:51], s13 offen lds
    s_add_u32 m0, s10, 81920
    s_add_u32 s13, s69, 262208
    buffer_load_dwordx4 v126, s[48:51], s13 offen lds
    v_exp_f32 v113, v113
    v_exp_f32 v114, v114
    v_exp_f32 v115, v115
    v_exp_f32 v116, v116
    v_exp_f32 v117, v117
    v_smfmac_f32_32x32x32_bf16 v[76:91], v[20:23], v[108:115], v43
    v_exp_f32 v118, v118
    v_exp_f32 v119, v119
    v_exp_f32 v120, v120
    v_exp_f32 v121, v121
    v_exp_f32 v122, v122
    v_exp_f32 v123, v123
    v_exp_f32 v92, v92
    v_exp_f32 v93, v93
    v_smfmac_f32_32x32x32_bf16 v[76:91], v[24:27], v[116:123], v43
    s_mov_b64 exec, s[60:61]
    ds_read_b128 v[20:23], v2 offset:50176
    ds_read_b128 v[24:27], v2 offset:49920
    s_mov_b64 exec, -1
    v_exp_f32 v94, v94
    v_exp_f32 v95, v95
    v_exp_f32 v96, v96
    v_mfma_f32_32x32x16_bf16 v[108:123], v[16:19], v[8:11], v[44:59]
    ds_read_b128 v[12:15], v2 offset:49152
    s_waitcnt vmcnt(8)
    ds_read_b64_tr_b16 v[232:233], v42 offset:8192
    ds_read_b64_tr_b16 v[234:235], v42 offset:8448
    ds_read_b64_tr_b16 v[236:237], v42 offset:24576
    ds_read_b64_tr_b16 v[238:239], v42 offset:24832
    v_exp_f32 v97, v97
    v_exp_f32 v98, v98
    v_exp_f32 v99, v99
    v_exp_f32 v100, v100
    v_exp_f32 v101, v101
    v_smfmac_f32_32x32x32_bf16 v[60:75], v[28:31], v[92:99], v43
    v_exp_f32 v102, v102
    v_exp_f32 v103, v103
    v_exp_f32 v104, v104
    v_exp_f32 v105, v105
    v_exp_f32 v106, v106
    v_exp_f32 v107, v107
    s_setprio 2
    v_exp_f32 v108, v108
    v_exp_f32 v109, v109
    v_smfmac_f32_32x32x32_bf16 v[60:75], v[32:35], v[100:107], v43
    v_exp_f32 v110, v110
    v_exp_f32 v111, v111
    v_exp_f32 v112, v112
    s_waitcnt lgkmcnt(0)
    v_mfma_f32_32x32x16_bf16 v[92:107], v[12:15], v[4:7], v[44:59]
    s_add_u32 m0, s10, 73728
    s_add_u32 s13, s69, 393216
    buffer_load_dwordx4 v126, s[48:51], s13 offen lds
    s_add_u32 m0, s10, 90112
    s_add_u32 s13, s69, 393280
    buffer_load_dwordx4 v126, s[48:51], s13 offen lds
    v_exp_f32 v113, v113
    v_exp_f32 v114, v114
    v_exp_f32 v115, v115
    v_exp_f32 v116, v116
    v_exp_f32 v117, v117
    v_smfmac_f32_32x32x32_bf16 v[76:91], v[28:31], v[108:115], v43
    v_exp_f32 v118, v118
    v_exp_f32 v119, v119
    v_exp_f32 v120, v120
    v_exp_f32 v121, v121
    v_exp_f32 v122, v122
    v_exp_f32 v123, v123
    v_exp_f32 v92, v92
    v_exp_f32 v93, v93
    v_smfmac_f32_32x32x32_bf16 v[76:91], v[32:35], v[116:123], v43
    s_mov_b64 exec, s[60:61]
    ds_read_b128 v[28:31], v2 offset:52224
    ds_read_b128 v[32:35], v2 offset:51968
    s_mov_b64 exec, -1
    s_add_u32 s13, s62, 1
    s_and_b32 s14, s13, 7
    s_lshr_b32 s13, s13, 3
    s_lshl_b32 s13, s13, 14
    s_lshl_b32 s14, s14, 7
    s_add_u32 s13, s13, s14
    buffer_load_dword v127, v126, s[56:59], s13 offen
    s_add_u32 s13, s62, 2
    s_and_b32 s14, s13, 7
    s_lshr_b32 s13, s13, 3
    s_lshl_b32 s13, s13, 14
    s_lshl_b32 s14, s14, 7
    s_add_u32 s13, s13, s14
    buffer_load_dword v127, v126, s[56:59], s13 offen
    v_exp_f32 v94, v94
    v_exp_f32 v95, v95
    v_exp_f32 v96, v96
    v_mfma_f32_32x32x16_bf16 v[108:123], v[12:15], v[8:11], v[44:59]
    ds_read_b128 v[16:19], v2 offset:51200
    s_waitcnt vmcnt(10)
    ds_read_b64_tr_b16 v[240:241], v124 offset:0
    ds_read_b64_tr_b16 v[242:243], v124 offset:256
    ds_read_b64_tr_b16 v[244:245], v124 offset:1024
    ds_read_b64_tr_b16 v[246:247], v124 offset:1280
    v_exp_f32 v97, v97
    v_exp_f32 v98, v98
    v_exp_f32 v99, v99
    v_exp_f32 v100, v100
    v_exp_f32 v101, v101
    v_smfmac_f32_32x32x32_bf16 v[60:75], v[20:23], v[92:99], v43
    v_exp_f32 v102, v102
    v_exp_f32 v103, v103
    v_exp_f32 v104, v104
    v_exp_f32 v105, v105
    v_exp_f32 v106, v106
    v_exp_f32 v107, v107
    v_exp_f32 v108, v108
    v_exp_f32 v109, v109
    v_smfmac_f32_32x32x32_bf16 v[60:75], v[24:27], v[100:107], v43
    v_exp_f32 v110, v110
    v_exp_f32 v111, v111
    v_exp_f32 v112, v112
    s_waitcnt lgkmcnt(0)
    v_mfma_f32_32x32x16_bf16 v[92:107], v[16:19], v[4:7], v[44:59]
    v_exp_f32 v113, v113
    v_exp_f32 v114, v114
    v_exp_f32 v115, v115
    v_exp_f32 v116, v116
    v_exp_f32 v117, v117
    v_smfmac_f32_32x32x32_bf16 v[76:91], v[20:23], v[108:115], v43
    v_exp_f32 v118, v118
    v_exp_f32 v119, v119
    v_exp_f32 v120, v120
    v_exp_f32 v121, v121
    v_exp_f32 v122, v122
    v_exp_f32 v123, v123
    v_exp_f32 v92, v92
    v_exp_f32 v93, v93
    v_smfmac_f32_32x32x32_bf16 v[76:91], v[24:27], v[116:123], v43
    s_mov_b64 exec, s[60:61]
    ds_read_b128 v[20:23], v2 offset:54272
    ds_read_b128 v[24:27], v2 offset:54016
    s_mov_b64 exec, -1
    v_exp_f32 v94, v94
    v_exp_f32 v95, v95
    v_exp_f32 v96, v96
    v_mfma_f32_32x32x16_bf16 v[108:123], v[16:19], v[8:11], v[44:59]
    ds_read_b128 v[12:15], v2 offset:53248
    s_waitcnt vmcnt(8)
    ds_read_b64_tr_b16 v[248:249], v41 offset:0
    ds_read_b64_tr_b16 v[250:251], v41 offset:256
    ds_read_b64_tr_b16 v[252:253], v41 offset:16384
    ds_read_b64_tr_b16 v[254:255], v41 offset:16640
    v_exp_f32 v97, v97
    v_exp_f32 v98, v98
    v_exp_f32 v99, v99
    v_exp_f32 v100, v100
    v_exp_f32 v101, v101
    v_smfmac_f32_32x32x32_bf16 v[60:75], v[28:31], v[92:99], v43
    v_exp_f32 v102, v102
    v_exp_f32 v103, v103
    v_exp_f32 v104, v104
    v_exp_f32 v105, v105
    v_exp_f32 v106, v106
    v_exp_f32 v107, v107
    v_exp_f32 v108, v108
    v_exp_f32 v109, v109
    v_smfmac_f32_32x32x32_bf16 v[60:75], v[32:35], v[100:107], v43
    v_exp_f32 v110, v110
    v_exp_f32 v111, v111
    v_exp_f32 v112, v112
    s_waitcnt lgkmcnt(0)
    v_mfma_f32_32x32x16_bf16 v[92:107], v[12:15], v[4:7], v[44:59]
    s_add_u32 m0, s10, 0
    s_add_u32 s13, s69, 0
    buffer_load_dwordx4 v126, s[48:51], s13 offen lds
    s_add_u32 m0, s10, 16384
    s_add_u32 s13, s69, 64
    buffer_load_dwordx4 v126, s[48:51], s13 offen lds
    v_exp_f32 v113, v113
    v_exp_f32 v114, v114
    v_exp_f32 v115, v115
    v_exp_f32 v116, v116
    v_exp_f32 v117, v117
    v_smfmac_f32_32x32x32_bf16 v[76:91], v[28:31], v[108:115], v43
    v_exp_f32 v118, v118
    v_exp_f32 v119, v119
    v_exp_f32 v120, v120
    v_exp_f32 v121, v121
    v_exp_f32 v122, v122
    v_exp_f32 v123, v123
    v_exp_f32 v92, v92
    v_exp_f32 v93, v93
    v_smfmac_f32_32x32x32_bf16 v[76:91], v[32:35], v[116:123], v43
    s_mov_b64 exec, s[60:61]
    ds_read_b128 v[28:31], v2 offset:56320
    ds_read_b128 v[32:35], v2 offset:56064
    s_mov_b64 exec, -1
    buffer_load_dword v127, v3, s[52:55], s64 offen offset:0 sc1
    buffer_load_dword v127, v3, s[52:55], s64 offen offset:1024 sc1
    v_exp_f32 v94, v94
    v_exp_f32 v95, v95
    v_exp_f32 v96, v96
    v_mfma_f32_32x32x16_bf16 v[108:123], v[12:15], v[8:11], v[44:59]
    ds_read_b128 v[16:19], v2 offset:55296
    v_exp_f32 v97, v97
    v_exp_f32 v98, v98
    v_exp_f32 v99, v99
    v_exp_f32 v100, v100
    v_exp_f32 v101, v101
    v_smfmac_f32_32x32x32_bf16 v[60:75], v[20:23], v[92:99], v43
    v_exp_f32 v102, v102
    v_exp_f32 v103, v103
    v_exp_f32 v104, v104
    v_exp_f32 v105, v105
    v_exp_f32 v106, v106
    v_exp_f32 v107, v107
    v_exp_f32 v108, v108
    v_exp_f32 v109, v109
    v_smfmac_f32_32x32x32_bf16 v[60:75], v[24:27], v[100:107], v43
    v_exp_f32 v110, v110
    v_exp_f32 v111, v111
    v_exp_f32 v112, v112
    s_waitcnt lgkmcnt(0)
    v_mfma_f32_32x32x16_bf16 v[92:107], v[16:19], v[4:7], v[44:59]
    v_exp_f32 v113, v113
    v_exp_f32 v114, v114
    v_exp_f32 v115, v115
    v_exp_f32 v116, v116
    v_exp_f32 v117, v117
    v_smfmac_f32_32x32x32_bf16 v[76:91], v[20:23], v[108:115], v43
    v_exp_f32 v118, v118
    v_exp_f32 v119, v119
    v_exp_f32 v120, v120
    v_exp_f32 v121, v121
    v_exp_f32 v122, v122
    v_exp_f32 v123, v123
    v_exp_f32 v92, v92
    v_exp_f32 v93, v93
    v_smfmac_f32_32x32x32_bf16 v[76:91], v[24:27], v[116:123], v43
    s_mov_b64 exec, s[60:61]
    ds_read_b128 v[20:23], v2 offset:58368
    ds_read_b128 v[24:27], v2 offset:58112
    s_mov_b64 exec, -1
    buffer_load_dword v127, v3, s[52:55], s95 offen offset:0 sc1
    buffer_load_dword v127, v3, s[84:87], s67 offen
    v_exp_f32 v94, v94
    v_exp_f32 v95, v95
    v_exp_f32 v96, v96
    v_mfma_f32_32x32x16_bf16 v[108:123], v[16:19], v[8:11], v[44:59]
    ds_read_b128 v[12:15], v2 offset:57344
    v_exp_f32 v97, v97
    v_exp_f32 v98, v98
    v_exp_f32 v99, v99
    v_exp_f32 v100, v100
    v_exp_f32 v101, v101
    v_smfmac_f32_32x32x32_bf16 v[60:75], v[28:31], v[92:99], v43
    v_exp_f32 v102, v102
    v_exp_f32 v103, v103
    v_exp_f32 v104, v104
    v_exp_f32 v105, v105
    v_exp_f32 v106, v106
    v_exp_f32 v107, v107
    v_exp_f32 v108, v108
    v_exp_f32 v109, v109
    v_smfmac_f32_32x32x32_bf16 v[60:75], v[32:35], v[100:107], v43
    v_exp_f32 v110, v110
    v_exp_f32 v111, v111
    v_exp_f32 v112, v112
    s_waitcnt lgkmcnt(0)
    v_mfma_f32_32x32x16_bf16 v[92:107], v[12:15], v[4:7], v[44:59]
    v_exp_f32 v113, v113
    v_exp_f32 v114, v114
    v_exp_f32 v115, v115
    v_exp_f32 v116, v116
    v_exp_f32 v117, v117
    v_smfmac_f32_32x32x32_bf16 v[76:91], v[28:31], v[108:115], v43
    v_exp_f32 v118, v118
    v_exp_f32 v119, v119
    v_exp_f32 v120, v120
    v_exp_f32 v121, v121
    v_exp_f32 v122, v122
    v_exp_f32 v123, v123
    v_exp_f32 v92, v92
    v_exp_f32 v93, v93
    v_smfmac_f32_32x32x32_bf16 v[76:91], v[32:35], v[116:123], v43
    s_mov_b64 exec, s[60:61]
    ds_read_b128 v[28:31], v2 offset:60416
    ds_read_b128 v[32:35], v2 offset:60160
    s_mov_b64 exec, -1
    buffer_load_dword v127, v3, s[88:91], 0 offen
    s_getpc_b64 s[14:15]
L_cqf:
    s_add_u32 s14, s14, L_k2_done-L_cqf
    s_addc_u32 s15, s15, 0
    s_and_b32 s13, s5, 1
    s_lshl_b32 s13, s13, 13
    s_add_u32 s13, s13, s10
    s_add_u32 s14, s14, s13
    s_addc_u32 s15, s15, 0
    global_load_dword v127, v3, s[14:15]
    v_exp_f32 v94, v94
    v_exp_f32 v95, v95
    v_exp_f32 v96, v96
    v_mfma_f32_32x32x16_bf16 v[108:123], v[12:15], v[8:11], v[44:59]
    ds_read_b128 v[16:19], v2 offset:59392
    v_exp_f32 v97, v97
    v_exp_f32 v98, v98
    v_exp_f32 v99, v99
    v_exp_f32 v100, v100
    v_exp_f32 v101, v101
    v_smfmac_f32_32x32x32_bf16 v[60:75], v[20:23], v[92:99], v43
    v_exp_f32 v102, v102
    v_exp_f32 v103, v103
    v_exp_f32 v104, v104
    v_exp_f32 v105, v105
    v_exp_f32 v106, v106
    v_exp_f32 v107, v107
    v_exp_f32 v108, v108
    v_exp_f32 v109, v109
    v_smfmac_f32_32x32x32_bf16 v[60:75], v[24:27], v[100:107], v43
    v_exp_f32 v110, v110
    v_exp_f32 v111, v111
    v_exp_f32 v112, v112
    s_waitcnt lgkmcnt(0)
    v_mfma_f32_32x32x16_bf16 v[92:107], v[16:19], v[4:7], v[44:59]
    v_exp_f32 v113, v113
    v_exp_f32 v114, v114
    v_exp_f32 v115, v115
    v_exp_f32 v116, v116
    v_exp_f32 v117, v117
    v_smfmac_f32_32x32x32_bf16 v[76:91], v[20:23], v[108:115], v43
    v_exp_f32 v118, v118
    v_exp_f32 v119, v119
    v_exp_f32 v120, v120
    v_exp_f32 v121, v121
    v_exp_f32 v122, v122
    v_exp_f32 v123, v123
    v_exp_f32 v92, v92
    v_exp_f32 v93, v93
    v_smfmac_f32_32x32x32_bf16 v[76:91], v[24:27], v[116:123], v43
    s_mov_b64 exec, s[60:61]
    ds_read_b128 v[20:23], v2 offset:62464
    ds_read_b128 v[24:27], v2 offset:62208
    s_mov_b64 exec, -1
    v_exp_f32 v94, v94
    v_exp_f32 v95, v95
    v_exp_f32 v96, v96
    v_mfma_f32_32x32x16_bf16 v[108:123], v[16:19], v[8:11], v[44:59]
    ds_read_b128 v[12:15], v2 offset:61440
    v_exp_f32 v97, v97
    v_exp_f32 v98, v98
    v_exp_f32 v99, v99
    v_exp_f32 v100, v100
    v_exp_f32 v101, v101
    v_smfmac_f32_32x32x32_bf16 v[60:75], v[28:31], v[92:99], v43
    v_exp_f32 v102, v102
    v_exp_f32 v103, v103
    v_exp_f32 v104, v104
    v_exp_f32 v105, v105
    v_exp_f32 v106, v106
    v_exp_f32 v107, v107
    s_setprio 1
    v_exp_f32 v108, v108
    v_exp_f32 v109, v109
    v_smfmac_f32_32x32x32_bf16 v[60:75], v[32:35], v[100:107], v43
    v_exp_f32 v110, v110
    v_exp_f32 v111, v111
    v_exp_f32 v112, v112
    s_waitcnt lgkmcnt(0)
    v_mfma_f32_32x32x16_bf16 v[92:107], v[12:15], v[4:7], v[44:59]
    buffer_load_dword v127, v3, s[52:55], s68 offen sc1
    v_exp_f32 v113, v113
    v_exp_f32 v114, v114
    v_exp_f32 v115, v115
    v_exp_f32 v116, v116
    v_exp_f32 v117, v117
    v_smfmac_f32_32x32x32_bf16 v[76:91], v[28:31], v[108:115], v43
    v_exp_f32 v118, v118
    v_exp_f32 v119, v119
    v_exp_f32 v120, v120
    v_exp_f32 v121, v121
    v_exp_f32 v122, v122
    v_exp_f32 v123, v123
    v_exp_f32 v92, v92
    v_exp_f32 v93, v93
    v_smfmac_f32_32x32x32_bf16 v[76:91], v[32:35], v[116:123], v43
    s_mov_b64 exec, s[60:61]
    ds_read_b128 v[28:31], v2 offset:64512
    ds_read_b128 v[32:35], v2 offset:64256
    s_mov_b64 exec, -1
    v_exp_f32 v94, v94
    v_exp_f32 v95, v95
    v_exp_f32 v96, v96
    v_mfma_f32_32x32x16_bf16 v[108:123], v[12:15], v[8:11], v[44:59]
    ds_read_b128 v[16:19], v2 offset:63488
    v_exp_f32 v97, v97
    v_exp_f32 v98, v98
    v_exp_f32 v99, v99
    v_exp_f32 v100, v100
    v_exp_f32 v101, v101
    v_smfmac_f32_32x32x32_bf16 v[60:75], v[20:23], v[92:99], v43
    v_exp_f32 v102, v102
    v_exp_f32 v103, v103
    v_exp_f32 v104, v104
    v_exp_f32 v105, v105
    v_exp_f32 v106, v106
    v_exp_f32 v107, v107
    v_exp_f32 v108, v108
    v_exp_f32 v109, v109
    v_smfmac_f32_32x32x32_bf16 v[60:75], v[24:27], v[100:107], v43
    v_exp_f32 v110, v110
    v_exp_f32 v111, v111
    v_exp_f32 v112, v112
    s_waitcnt lgkmcnt(0)
    v_mfma_f32_32x32x16_bf16 v[92:107], v[16:19], v[4:7], v[44:59]
    v_exp_f32 v113, v113
    v_exp_f32 v114, v114
    v_exp_f32 v115, v115
    v_exp_f32 v116, v116
    v_exp_f32 v117, v117
    v_smfmac_f32_32x32x32_bf16 v[76:91], v[20:23], v[108:115], v43
    v_exp_f32 v118, v118
    v_exp_f32 v119, v119
    v_exp_f32 v120, v120
    v_exp_f32 v121, v121
    v_exp_f32 v122, v122
    v_exp_f32 v123, v123
    v_exp_f32 v92, v92
    v_exp_f32 v93, v93
    v_smfmac_f32_32x32x32_bf16 v[76:91], v[24:27], v[116:123], v43
    v_exp_f32 v94, v94
    v_exp_f32 v95, v95
    v_exp_f32 v96, v96
    v_mfma_f32_32x32x16_bf16 v[108:123], v[16:19], v[8:11], v[44:59]
    v_exp_f32 v97, v97
    v_exp_f32 v98, v98
    v_exp_f32 v99, v99
    v_exp_f32 v100, v100
    v_exp_f32 v101, v101
    v_smfmac_f32_32x32x32_bf16 v[60:75], v[28:31], v[92:99], v43
    v_exp_f32 v102, v102
    v_exp_f32 v103, v103
    v_exp_f32 v104, v104
    v_exp_f32 v105, v105
    v_exp_f32 v106, v106
    v_exp_f32 v107, v107
    s_setprio 0
    v_exp_f32 v108, v108
    v_exp_f32 v109, v109
    v_smfmac_f32_32x32x32_bf16 v[60:75], v[32:35], v[100:107], v43
    v_exp_f32 v110, v110
    v_exp_f32 v111, v111
    v_exp_f32 v112, v112
    s_waitcnt lgkmcnt(0)
    s_waitcnt vmcnt(0)
    v_cmp_ne_u32 vcc, s42, v127
    s_or_b32 s42, vcc_lo, vcc_hi
    s_and_b32 s42, s42, 0x01010101
    v_exp_f32 v113, v113
    v_exp_f32 v114, v114
    v_exp_f32 v115, v115
    v_exp_f32 v116, v116
    v_exp_f32 v117, v117
    v_smfmac_f32_32x32x32_bf16 v[76:91], v[28:31], v[108:115], v43
    v_exp_f32 v118, v118
    v_exp_f32 v119, v119
    v_exp_f32 v120, v120
    v_exp_f32 v121, v121
    v_exp_f32 v122, v122
    v_exp_f32 v123, v123
    s_nop 3
L_k2_done:
    v_smfmac_f32_32x32x32_bf16 v[76:91], v[32:35], v[116:123], v43
    s_setprio 0
    v_add_u32 v6, s66, v3
    v_xor_b32 v7, 0x4000, v6
    v_lshl_add_u32 v16, v1, 2, s66
    v_xor_b32 v17, 0x4000, v16
    v_and_b32 v5, 7, v1
    v_and_b32 v18, 31, v1
    v_lshrrev_b32 v11, 5, v1
    v_lshlrev_b32 v11, 4, v11
    v_lshl_or_b32 v10, v18, 10, v11
    v_xor_b32 v9, s38, v124
    v_add_u32 v8, s32, v3
    buffer_load_dwordx4 v[12:15], v10, s[76:79], s74 offen
    ds_write_b128 v6, v[84:87]
    ds_write_b128 v6, v[88:91] offset:1024
    ds_write_b32 v16, v76 offset:2048
    v_cmp_eq_u32 vcc, 0, v18
    v_cmp_eq_u32 s[14:15], 17, v18
    s_or_b64 vcc, vcc, s[14:15]
    v_mov_b32 v55, s83
    v_and_b32 v4, 0x380, v3
    v_lshl_or_b32 v5, v5, 2, v4
    s_waitcnt lgkmcnt(0)
    s_barrier
    ds_read_b32 v18, v17 offset:2048
    ds_read_b128 v[92:95], v7
    ds_read_b128 v[96:99], v7 offset:1024
    v_cndmask_b32 v56, 0, v55, vcc
    v_mov_b32 v57, v56
    v_mov_b64 v[58:59], v[56:57]
    v_lshrrev_b32 v20, 4, v1
    v_lshlrev_b32 v20, 9, v20
    v_and_b32 v21, 15, v1
    v_lshl_or_b32 v8, v21, 4, v20
    v_add_u32 v8, s32, v8
    v_bfe_u32 v21, v1, 2, 2
    v_lshl_or_b32 v20, v21, 6, v20
    v_and_b32 v21, 3, v1
    v_lshl_or_b32 v20, v21, 3, v20
    v_and_b32 v21, 16, v1
    v_lshl_or_b32 v20, v21, 1, v20
    v_xor_b32 v9, s38, v20
    v_add_u32 v6, 0x10000, v9
    s_waitcnt lgkmcnt(2)
    v_add_f32 v18, v18, v60
    v_rcp_f32 v18, v18
    s_waitcnt lgkmcnt(0)
    v_pk_add_f32 v[68:69], v[68:69], v[92:93]
    v_pk_add_f32 v[70:71], v[70:71], v[94:95]
    v_pk_add_f32 v[72:73], v[72:73], v[96:97]
    v_pk_add_f32 v[74:75], v[74:75], v[98:99]
    v_pk_mul_f32 v[68:69], v[18:19], v[68:69] op_sel_hi:[0,1]
    v_pk_mul_f32 v[70:71], v[18:19], v[70:71] op_sel_hi:[0,1]
    v_pk_mul_f32 v[72:73], v[18:19], v[72:73] op_sel_hi:[0,1]
    v_pk_mul_f32 v[74:75], v[18:19], v[74:75] op_sel_hi:[0,1]
    v_cvt_pk_bf16_f32 v36, v68, v69
    v_cvt_pk_bf16_f32 v37, v70, v71
    v_cvt_pk_bf16_f32 v38, v72, v73
    v_cvt_pk_bf16_f32 v39, v74, v75
    buffer_store_dwordx4 v[36:39], v3, s[52:55], s63 offen
    v_mov_b32 v4, 1
    v_mfma_f32_16x16x32_bf16 v[52:55], v[56:59], v[128:131], 0
    v_mfma_f32_16x16x32_bf16 v[52:55], v[56:59], v[132:135], v[52:55]
    v_mfma_f32_16x16x32_bf16 v[52:55], v[56:59], v[136:139], v[52:55]
    v_mfma_f32_16x16x32_bf16 v[52:55], v[56:59], v[140:143], v[52:55]
    s_cmp_eq_u32 s42, 0
    s_waitcnt vmcnt(0) lgkmcnt(0)
    s_mov_b64 exec, 1
    s_cbranch_scc0 L_x1_slow
    buffer_store_dword v4, v5, s[52:55], s24 offen offset:32
L_x1_set:
    s_mov_b64 exec, s[8:9]
    buffer_load_dword v4, v5, s[52:55], s68 offen offset:32 sc1
    s_mov_b64 exec, -1
    v_mfma_f32_16x16x32_bf16 v[52:55], v[56:59], v[144:147], v[52:55]
    v_mfma_f32_16x16x32_bf16 v[52:55], v[56:59], v[148:151], v[52:55]
    v_mfma_f32_16x16x32_bf16 v[52:55], v[56:59], v[152:155], v[52:55]
    v_mfma_f32_16x16x32_bf16 v[52:55], v[56:59], v[156:159], v[52:55]
    v_mfma_f32_16x16x32_bf16 v[52:55], v[56:59], v[160:163], v[52:55]
    v_mfma_f32_16x16x32_bf16 v[52:55], v[56:59], v[164:167], v[52:55]
    v_mfma_f32_16x16x32_bf16 v[52:55], v[56:59], v[168:171], v[52:55]
    v_mfma_f32_16x16x32_bf16 v[52:55], v[56:59], v[172:175], v[52:55]
    s_mov_b64 exec, s[8:9]
    s_mov_b32 s13, 0
    s_waitcnt vmcnt(0)
    v_cmp_eq_u32 vcc, 0, v4
    s_cbranch_vccz L_x1_out
    buffer_load_dword v4, v5, s[52:55], s68 offen offset:32 sc1
L_x1_poll:
    buffer_load_dword v2, v5, s[52:55], s68 offen offset:32 sc1
    s_waitcnt vmcnt(1)
    v_cmp_eq_u32 vcc, 0, v4
    s_cbranch_vccz L_x1_out
    buffer_load_dword v4, v5, s[52:55], s68 offen offset:32 sc1
    s_waitcnt vmcnt(1)
    v_cmp_eq_u32 vcc, 0, v2
    s_cbranch_vccz L_x1_out
    s_add_u32 s13, s13, 1
    s_cmp_lt_u32 s13, 1048576
    s_cbranch_scc1 L_x1_poll
L_x1_out:
    s_mov_b64 exec, -1
    s_cmp_eq_u32 s42, 0
    s_cbranch_scc0 L_x1_inv
L_x1_go:
    s_add_u32 m0, s6, 32768
    s_add_u32 s13, s7, 0
    buffer_load_dwordx4 v3, s[52:55], s13 offen offset:0 sc1 lds
    buffer_load_dwordx4 v3, s[52:55], s13 offen offset:1024 sc1 lds
    s_add_u32 m0, s6, 98304
    s_add_u32 s13, s7, 32768
    buffer_load_dwordx4 v3, s[52:55], s13 offen offset:0 sc1 lds
    buffer_load_dwordx4 v3, s[52:55], s13 offen offset:1024 sc1 lds
    s_add_u32 m0, s6, 32768
    s_add_u32 s13, s7, 0
    buffer_load_dwordx4 v3, s[52:55], s13 offen offset:2048 sc1 lds
    buffer_load_dwordx4 v3, s[52:55], s13 offen offset:3072 sc1 lds
    s_add_u32 m0, s6, 98304
    s_add_u32 s13, s7, 32768
    buffer_load_dwordx4 v3, s[52:55], s13 offen offset:2048 sc1 lds
    buffer_load_dwordx4 v3, s[52:55], s13 offen offset:3072 sc1 lds
    ds_read_b64_tr_b16 v[60:61], v9 offset:0
    ds_read_b64_tr_b16 v[62:63], v9 offset:256
    v_mfma_f32_16x16x32_bf16 v[52:55], v[56:59], v[176:179], v[52:55]
    ds_read_b64_tr_b16 v[64:65], v9 offset:4096
    ds_read_b64_tr_b16 v[66:67], v9 offset:4352
    v_mfma_f32_16x16x32_bf16 v[52:55], v[56:59], v[180:183], v[52:55]
    ds_read_b64_tr_b16 v[68:69], v9 offset:8192
    ds_read_b64_tr_b16 v[70:71], v9 offset:8448
    v_mfma_f32_16x16x32_bf16 v[52:55], v[56:59], v[184:187], v[52:55]
    ds_read_b64_tr_b16 v[72:73], v9 offset:12288
    ds_read_b64_tr_b16 v[74:75], v9 offset:12544
    v_mfma_f32_16x16x32_bf16 v[52:55], v[56:59], v[188:191], v[52:55]
    ds_read_b64_tr_b16 v[76:77], v6 offset:0
    ds_read_b64_tr_b16 v[78:79], v6 offset:256
    ds_read_b64_tr_b16 v[80:81], v6 offset:4096
    ds_read_b64_tr_b16 v[82:83], v6 offset:4352
    ds_read_b64_tr_b16 v[84:85], v6 offset:8192
    ds_read_b64_tr_b16 v[86:87], v6 offset:8448
    ds_read_b64_tr_b16 v[88:89], v6 offset:12288
    ds_read_b64_tr_b16 v[90:91], v6 offset:12544
    ds_read_b64_tr_b16 v[92:93], v9 offset:2048
    ds_read_b64_tr_b16 v[94:95], v9 offset:2304
    ds_read_b64_tr_b16 v[96:97], v9 offset:6144
    ds_read_b64_tr_b16 v[98:99], v9 offset:6400
    ds_read_b64_tr_b16 v[100:101], v9 offset:10240
    ds_read_b64_tr_b16 v[102:103], v9 offset:10496
    ds_read_b64_tr_b16 v[104:105], v9 offset:14336
    ds_read_b64_tr_b16 v[106:107], v9 offset:14592
    ds_read_b64_tr_b16 v[108:109], v6 offset:2048
    ds_read_b64_tr_b16 v[110:111], v6 offset:2304
    ds_read_b64_tr_b16 v[112:113], v6 offset:6144
    ds_read_b64_tr_b16 v[114:115], v6 offset:6400
    ds_read_b64_tr_b16 v[116:117], v6 offset:10240
    ds_read_b64_tr_b16 v[118:119], v6 offset:10496
    ds_read_b64_tr_b16 v[120:121], v6 offset:14336
    ds_read_b64_tr_b16 v[122:123], v6 offset:14592
    v_permlane16_swap_b32 v12, v14
    v_permlane16_swap_b32 v13, v15
    s_nop 0
    v_lshlrev_b32 v16, 16, v12
    v_and_b32 v17, 0xffff0000, v12
    v_lshlrev_b32 v18, 16, v13
    v_and_b32 v19, 0xffff0000, v13
    v_lshlrev_b32 v20, 16, v14
    v_and_b32 v21, 0xffff0000, v14
    v_lshlrev_b32 v22, 16, v15
    v_and_b32 v23, 0xffff0000, v15
    v_xor_b32 v124, s39, v124
    v_and_b32 v127, 32, v1
    v_xor_b32 v124, v127, v124
    v_add_u32 v127, 0x10000, v124
    v_add_u32 v125, 0x24000, v124
    s_waitcnt lgkmcnt(0)
    s_waitcnt vmcnt(4)
    s_barrier
    ds_read_b128 v[24:27], v8 offset:0
    ds_read_b128 v[28:31], v8 offset:256
    ds_read_b128 v[32:35], v8 offset:4096
    ds_read_b128 v[36:39], v8 offset:4352
    ds_read_b128 v[40:43], v8 offset:8192
    ds_read_b128 v[44:47], v8 offset:8448
    s_waitcnt lgkmcnt(5)
    v_mfma_f32_16x16x32_bf16 v[16:19], v[60:63], v[24:27], v[16:19]
    s_waitcnt lgkmcnt(4)
    v_mfma_f32_16x16x32_bf16 v[20:23], v[60:63], v[28:31], v[20:23]
    ds_read_b128 v[24:27], v8 offset:12288
    ds_read_b128 v[28:31], v8 offset:12544
    s_waitcnt lgkmcnt(5)
    v_mfma_f32_16x16x32_bf16 v[16:19], v[64:67], v[32:35], v[16:19]
    s_waitcnt lgkmcnt(4)
    v_mfma_f32_16x16x32_bf16 v[20:23], v[64:67], v[36:39], v[20:23]
    ds_read_b128 v[32:35], v8 offset:16384
    ds_read_b128 v[36:39], v8 offset:16640
    s_waitcnt lgkmcnt(5)
    v_mfma_f32_16x16x32_bf16 v[16:19], v[68:71], v[40:43], v[16:19]
    s_waitcnt lgkmcnt(4)
    v_mfma_f32_16x16x32_bf16 v[20:23], v[68:71], v[44:47], v[20:23]
    ds_read_b128 v[40:43], v8 offset:20480
    ds_read_b128 v[44:47], v8 offset:20736
    s_waitcnt lgkmcnt(5)
    v_mfma_f32_16x16x32_bf16 v[16:19], v[72:75], v[24:27], v[16:19]
    s_waitcnt lgkmcnt(4)
    v_mfma_f32_16x16x32_bf16 v[20:23], v[72:75], v[28:31], v[20:23]
    ds_read_b128 v[24:27], v8 offset:24576
    ds_read_b128 v[28:31], v8 offset:24832
    s_waitcnt lgkmcnt(5)
    v_mfma_f32_16x16x32_bf16 v[16:19], v[76:79], v[32:35], v[16:19]
    s_waitcnt lgkmcnt(4)
    v_mfma_f32_16x16x32_bf16 v[20:23], v[76:79], v[36:39], v[20:23]
    ds_read_b128 v[32:35], v8 offset:28672
    ds_read_b128 v[36:39], v8 offset:28928
    s_waitcnt lgkmcnt(5)
    v_mfma_f32_16x16x32_bf16 v[16:19], v[80:83], v[40:43], v[16:19]
    s_waitcnt lgkmcnt(4)
    v_mfma_f32_16x16x32_bf16 v[20:23], v[80:83], v[44:47], v[20:23]
    s_waitcnt vmcnt(0)
    s_barrier
    ds_read_b128 v[40:43], v8 offset:2048
    ds_read_b128 v[44:47], v8 offset:2304
    s_waitcnt lgkmcnt(5)
    v_mfma_f32_16x16x32_bf16 v[16:19], v[84:87], v[24:27], v[16:19]
    s_waitcnt lgkmcnt(4)
    v_mfma_f32_16x16x32_bf16 v[20:23], v[84:87], v[28:31], v[20:23]
    ds_read_b128 v[24:27], v8 offset:6144
    ds_read_b128 v[28:31], v8 offset:6400
    s_add_u32 m0, s10, 0
    s_add_u32 s14, s97, 0
    buffer_load_dwordx4 v126, s[56:59], s14 offen lds
    s_waitcnt lgkmcnt(5)
    v_mfma_f32_16x16x32_bf16 v[16:19], v[88:91], v[32:35], v[16:19]
    s_waitcnt lgkmcnt(4)
    v_mfma_f32_16x16x32_bf16 v[20:23], v[88:91], v[36:39], v[20:23]
    ds_read_b128 v[32:35], v8 offset:10240
    ds_read_b128 v[36:39], v8 offset:10496
    s_add_u32 m0, s10, 8192
    s_add_u32 s14, s97, 720896
    buffer_load_dwordx4 v126, s[56:59], s14 offen lds
    s_waitcnt lgkmcnt(5)
    v_mfma_f32_16x16x32_bf16 v[16:19], v[92:95], v[40:43], v[16:19]
    s_waitcnt lgkmcnt(4)
    v_mfma_f32_16x16x32_bf16 v[20:23], v[92:95], v[44:47], v[20:23]
    ds_read_b128 v[40:43], v8 offset:14336
    ds_read_b128 v[44:47], v8 offset:14592
    s_add_u32 m0, s10, 16384
    s_add_u32 s14, s97, 16384
    buffer_load_dwordx4 v126, s[56:59], s14 offen lds
    s_waitcnt lgkmcnt(5)
    v_mfma_f32_16x16x32_bf16 v[16:19], v[96:99], v[24:27], v[16:19]
    s_waitcnt lgkmcnt(4)
    v_mfma_f32_16x16x32_bf16 v[20:23], v[96:99], v[28:31], v[20:23]
    ds_read_b128 v[24:27], v8 offset:18432
    ds_read_b128 v[28:31], v8 offset:18688
    s_add_u32 m0, s10, 24576
    s_add_u32 s14, s97, 737280
    buffer_load_dwordx4 v126, s[56:59], s14 offen lds
    s_waitcnt lgkmcnt(5)
    v_mfma_f32_16x16x32_bf16 v[16:19], v[100:103], v[32:35], v[16:19]
    s_waitcnt lgkmcnt(4)
    v_mfma_f32_16x16x32_bf16 v[20:23], v[100:103], v[36:39], v[20:23]
    ds_read_b128 v[32:35], v8 offset:22528
    ds_read_b128 v[36:39], v8 offset:22784
    s_waitcnt lgkmcnt(5)
    v_mfma_f32_16x16x32_bf16 v[16:19], v[104:107], v[40:43], v[16:19]
    s_waitcnt lgkmcnt(4)
    v_mfma_f32_16x16x32_bf16 v[20:23], v[104:107], v[44:47], v[20:23]
    ds_read_b128 v[40:43], v8 offset:26624
    ds_read_b128 v[44:47], v8 offset:26880
    s_waitcnt lgkmcnt(5)
    v_mfma_f32_16x16x32_bf16 v[16:19], v[108:111], v[24:27], v[16:19]
    s_waitcnt lgkmcnt(4)
    v_mfma_f32_16x16x32_bf16 v[20:23], v[108:111], v[28:31], v[20:23]
    ds_read_b128 v[24:27], v8 offset:30720
    ds_read_b128 v[28:31], v8 offset:30976
    s_waitcnt lgkmcnt(5)
    v_mfma_f32_16x16x32_bf16 v[16:19], v[112:115], v[32:35], v[16:19]
    s_waitcnt lgkmcnt(4)
    v_mfma_f32_16x16x32_bf16 v[20:23], v[112:115], v[36:39], v[20:23]
    buffer_load_dwordx4 v[80:83], v11, s[84:87], s67 offen
    buffer_load_dwordx4 v[84:87], v11, s[84:87], s67 offen offset:32
    s_waitcnt lgkmcnt(3)
    v_mfma_f32_16x16x32_bf16 v[16:19], v[116:119], v[40:43], v[16:19]
    s_waitcnt lgkmcnt(2)
    v_mfma_f32_16x16x32_bf16 v[20:23], v[116:119], v[44:47], v[20:23]
    s_waitcnt lgkmcnt(1)
    v_mfma_f32_16x16x32_bf16 v[16:19], v[120:123], v[24:27], v[16:19]
    s_waitcnt lgkmcnt(0)
    v_mfma_f32_16x16x32_bf16 v[20:23], v[120:123], v[28:31], v[20:23]
    v_mov_b64 v[60:61], 0
    v_lshlrev_b32 v64, 3, v1
    v_and_b32 v9, 31, v1
    v_lshlrev_b32 v8, 3, v9
    v_lshl_add_u32 v8, v11, 9, v8
    v_add_u32 v8, s29, v8
    v_lshl_add_u32 v9, v9, 4, s96
    v_add_u32 v7, s33, v3
    v_add_u32 v6, 0x10000, v7
    v_cvt_pk_bf16_f32 v12, v16, v17
    v_cvt_pk_bf16_f32 v13, v18, v19
    v_cvt_pk_bf16_f32 v14, v20, v21
    v_cvt_pk_bf16_f32 v15, v22, v23
    s_nop 1
    v_permlane16_swap_b32 v12, v14
    v_permlane16_swap_b32 v13, v15
    s_nop 0
    buffer_store_dwordx4 v[12:15], v3, s[52:55], s100 offen
    v_dot2c_f32_bf16 v60, s83, v12
    v_dot2c_f32_bf16 v61, v12, v12
    v_dot2c_f32_bf16 v60, s83, v13
    v_dot2c_f32_bf16 v61, v13, v13
    v_dot2c_f32_bf16 v60, s83, v14
    v_dot2c_f32_bf16 v61, v14, v14
    v_dot2c_f32_bf16 v60, s83, v15
    v_dot2c_f32_bf16 v61, v15, v15
    s_nop 2
    v_mov_b64 v[62:63], v[60:61]
    s_nop 1
    v_permlane32_swap_b32 v60, v62
    v_permlane32_swap_b32 v61, v63
    s_nop 0
    v_pk_add_f32 v[60:61], v[60:61], v[62:63]
    s_mov_b64 exec, 0xffffffff
    buffer_store_dwordx2 v[60:61], v64, s[52:55], s25 offen
    s_mov_b64 exec, -1
    v_mov_b32 v4, 1
    v_mfma_f32_16x16x32_bf16 v[52:55], v[56:59], v[192:195], v[52:55]
    v_mfma_f32_16x16x32_bf16 v[52:55], v[56:59], v[196:199], v[52:55]
    v_mfma_f32_16x16x32_bf16 v[52:55], v[56:59], v[200:203], v[52:55]
    v_mfma_f32_16x16x32_bf16 v[52:55], v[56:59], v[204:207], v[52:55]
    v_mfma_f32_16x16x32_bf16 v[52:55], v[56:59], v[208:211], v[52:55]
    v_mfma_f32_16x16x32_bf16 v[52:55], v[56:59], v[212:215], v[52:55]
    v_mfma_f32_16x16x32_bf16 v[52:55], v[56:59], v[216:219], v[52:55]
    v_mfma_f32_16x16x32_bf16 v[52:55], v[56:59], v[220:223], v[52:55]
    s_cmp_eq_u32 s42, 0
    s_waitcnt vmcnt(0) lgkmcnt(0)
    s_mov_b64 exec, 1
    s_cbranch_scc0 L_x2_slow
    buffer_store_dword v4, v5, s[52:55], s24 offen offset:64
L_x2_set:
    s_mov_b64 exec, s[8:9]
    buffer_load_dword v4, v5, s[52:55], s68 offen offset:64 sc1
    s_mov_b64 exec, -1
    v_mfma_f32_16x16x32_bf16 v[52:55], v[56:59], v[224:227], v[52:55]
    v_mfma_f32_16x16x32_bf16 v[52:55], v[56:59], v[228:231], v[52:55]
    v_mfma_f32_16x16x32_bf16 v[52:55], v[56:59], v[232:235], v[52:55]
    v_mfma_f32_16x16x32_bf16 v[52:55], v[56:59], v[236:239], v[52:55]
    v_mfma_f32_16x16x32_bf16 v[52:55], v[56:59], v[240:243], v[52:55]
    v_mfma_f32_16x16x32_bf16 v[52:55], v[56:59], v[244:247], v[52:55]
    v_mfma_f32_16x16x32_bf16 v[52:55], v[56:59], v[248:251], v[52:55]
    v_mfma_f32_16x16x32_bf16 v[52:55], v[56:59], v[252:255], v[52:55]
    v_lshlrev_b32 v64, 16, v80
    v_and_b32 v65, 0xffff0000, v80
    v_lshlrev_b32 v66, 16, v81
    v_and_b32 v67, 0xffff0000, v81
    v_lshlrev_b32 v68, 16, v82
    v_and_b32 v69, 0xffff0000, v82
    v_lshlrev_b32 v70, 16, v83
    v_and_b32 v71, 0xffff0000, v83
    v_lshlrev_b32 v72, 16, v84
    v_and_b32 v73, 0xffff0000, v84
    v_lshlrev_b32 v74, 16, v85
    v_and_b32 v75, 0xffff0000, v85
    v_lshlrev_b32 v76, 16, v86
    v_and_b32 v77, 0xffff0000, v86
    v_lshlrev_b32 v78, 16, v87
    v_and_b32 v79, 0xffff0000, v87
    s_barrier
    s_mov_b64 exec, s[8:9]
    s_mov_b32 s13, 0
    s_waitcnt vmcnt(0)
    v_cmp_eq_u32 vcc, 0, v4
    s_cbranch_vccz L_x2_out
    buffer_load_dword v4, v5, s[52:55], s68 offen offset:64 sc1
L_x2_poll:
    buffer_load_dword v2, v5, s[52:55], s68 offen offset:64 sc1
    s_waitcnt vmcnt(1)
    v_cmp_eq_u32 vcc, 0, v4
    s_cbranch_vccz L_x2_out
    buffer_load_dword v4, v5, s[52:55], s68 offen offset:64 sc1
    s_waitcnt vmcnt(1)
    v_cmp_eq_u32 vcc, 0, v2
    s_cbranch_vccz L_x2_out
    s_add_u32 s13, s13, 1
    s_cmp_lt_u32 s13, 1048576
    s_cbranch_scc1 L_x2_poll
L_x2_out:
    s_mov_b64 exec, -1
    s_cmp_eq_u32 s42, 0
    s_cbranch_scc0 L_x2_inv
L_x2_go:
    s_add_u32 m0, s6, 32768
    s_add_u32 s13, s7, 8388608
    buffer_load_dwordx4 v3, s[52:55], s13 offen offset:0 sc1 lds
    s_add_u32 m0, s6, 98304
    s_add_u32 s13, s7, 8421376
    buffer_load_dwordx4 v3, s[52:55], s13 offen offset:0 sc1 lds
    s_barrier
    s_mov_b32 m0, s27
    s_nop 0
    buffer_load_dwordx4 v3, s[52:55], s26 offen offset:0 sc1 lds
    buffer_load_dwordx4 v3, s[52:55], s26 offen offset:1024 sc1 lds
    s_add_u32 m0, s6, 32768
    s_add_u32 s13, s7, 8388608
    buffer_load_dwordx4 v3, s[52:55], s13 offen offset:1024 sc1 lds
    s_add_u32 m0, s6, 98304
    s_add_u32 s13, s7, 8421376
    buffer_load_dwordx4 v3, s[52:55], s13 offen offset:1024 sc1 lds
    s_add_u32 s13, s10, 155648
    v_lshl_add_u32 v48, v1, 2, s13
    v_add_u32 v39, s13, v11
    s_nop 3
    s_mov_b64 exec, 0xffff
    ds_write_b32 v48, v52
    ds_write_b32 v48, v53 offset:64
    s_mov_b64 exec, -1
    ds_read_b128 v[40:43], v39 offset:0
    ds_read_b128 v[44:47], v39 offset:32
    ds_read_b128 v[48:51], v39 offset:64
    ds_read_b128 v[52:55], v39 offset:96
    s_cmp_ge_u32 s3, 4
    s_cbranch_scc1 L_f1_s
    v_add_u32 v8, s66, v3
    s_waitcnt vmcnt(4)
    s_barrier
    ds_read_b128 v[96:99], v7 offset:0
    ds_read_b128 v[100:103], v6 offset:0
    ds_read_b128 v[104:107], v7 offset:4096
    ds_read_b128 v[108:111], v6 offset:4096
    ds_read_b128 v[120:123], v7 offset:8192
    s_add_u32 m0, s6, 32768
    s_add_u32 s13, s7, 8388608
    buffer_load_dwordx4 v3, s[52:55], s13 offen offset:2048 sc1 lds
    buffer_load_dwordx4 v3, s[52:55], s13 offen offset:3072 sc1 lds
    s_add_u32 m0, s6, 98304
    s_add_u32 s13, s7, 8421376
    buffer_load_dwordx4 v3, s[52:55], s13 offen offset:2048 sc1 lds
    buffer_load_dwordx4 v3, s[52:55], s13 offen offset:3072 sc1 lds
    s_waitcnt lgkmcnt(4)
    v_mfma_f32_32x32x16_bf16 v[16:31], v[128:131], v[96:99], 0
    ds_read_b128 v[96:99], v6 offset:8192
    s_waitcnt lgkmcnt(4)
    v_mfma_f32_32x32x16_bf16 v[80:95], v[128:131], v[100:103], 0
    ds_read_b128 v[100:103], v7 offset:12288
    s_waitcnt lgkmcnt(4)
    v_mfma_f32_32x32x16_bf16 v[16:31], v[132:135], v[104:107], v[16:31]
    ds_read_b128 v[104:107], v6 offset:12288
    s_waitcnt lgkmcnt(4)
    v_mfma_f32_32x32x16_bf16 v[80:95], v[132:135], v[108:111], v[80:95]
    ds_read_b128 v[108:111], v7 offset:16384
    s_waitcnt lgkmcnt(4)
    v_mfma_f32_32x32x16_bf16 v[16:31], v[136:139], v[120:123], v[16:31]
    ds_read_b128 v[120:123], v6 offset:16384
    s_waitcnt lgkmcnt(4)
    v_mfma_f32_32x32x16_bf16 v[80:95], v[136:139], v[96:99], v[80:95]
    ds_read_b128 v[96:99], v7 offset:20480
    s_waitcnt lgkmcnt(4)
    v_mfma_f32_32x32x16_bf16 v[16:31], v[140:143], v[100:103], v[16:31]
    ds_read_b128 v[100:103], v6 offset:20480
    s_waitcnt lgkmcnt(4)
    v_mfma_f32_32x32x16_bf16 v[80:95], v[140:143], v[104:107], v[80:95]
    ds_read_b128 v[104:107], v7 offset:24576
    s_waitcnt lgkmcnt(4)
    v_mfma_f32_32x32x16_bf16 v[16:31], v[144:147], v[108:111], v[16:31]
    s_waitcnt vmcnt(4)
    s_barrier
    ds_read_b128 v[108:111], v6 offset:24576
    s_waitcnt lgkmcnt(4)
    v_mfma_f32_32x32x16_bf16 v[80:95], v[144:147], v[120:123], v[80:95]
    ds_read_b128 v[120:123], v7 offset:28672
    s_waitcnt lgkmcnt(4)
    v_mfma_f32_32x32x16_bf16 v[16:31], v[148:151], v[96:99], v[16:31]
    ds_read_b128 v[96:99], v6 offset:28672
    s_waitcnt lgkmcnt(4)
    v_mfma_f32_32x32x16_bf16 v[80:95], v[148:151], v[100:103], v[80:95]
    ds_read_b128 v[100:103], v7 offset:1024
    s_waitcnt lgkmcnt(4)
    v_mfma_f32_32x32x16_bf16 v[16:31], v[152:155], v[104:107], v[16:31]
    ds_read_b128 v[104:107], v6 offset:1024
    s_waitcnt lgkmcnt(4)
    v_mfma_f32_32x32x16_bf16 v[80:95], v[152:155], v[108:111], v[80:95]
    ds_read_b128 v[108:111], v7 offset:5120
    s_waitcnt lgkmcnt(4)
    v_mfma_f32_32x32x16_bf16 v[16:31], v[156:159], v[120:123], v[16:31]
    ds_read_b128 v[120:123], v6 offset:5120
    s_waitcnt lgkmcnt(4)
    v_mfma_f32_32x32x16_bf16 v[80:95], v[156:159], v[96:99], v[80:95]
    ds_read_b128 v[96:99], v7 offset:9216
    s_waitcnt lgkmcnt(4)
    v_mfma_f32_32x32x16_bf16 v[16:31], v[160:163], v[100:103], v[16:31]
    ds_read_b128 v[100:103], v6 offset:9216
    s_waitcnt lgkmcnt(4)
    v_mfma_f32_32x32x16_bf16 v[80:95], v[160:163], v[104:107], v[80:95]
    ds_read_b128 v[104:107], v7 offset:13312
    s_waitcnt lgkmcnt(4)
    v_mfma_f32_32x32x16_bf16 v[16:31], v[164:167], v[108:111], v[16:31]
    ds_read_b128 v[108:111], v6 offset:13312
    s_waitcnt lgkmcnt(4)
    v_mfma_f32_32x32x16_bf16 v[80:95], v[164:167], v[120:123], v[80:95]
    ds_read_b128 v[120:123], v7 offset:17408
    s_waitcnt lgkmcnt(4)
    v_mfma_f32_32x32x16_bf16 v[16:31], v[168:171], v[96:99], v[16:31]
    s_waitcnt vmcnt(0)
    s_barrier
    ds_read_b128 v[96:99], v7 offset:21504
    s_waitcnt lgkmcnt(4)
    v_mfma_f32_32x32x16_bf16 v[80:95], v[168:171], v[100:103], v[80:95]
    ds_read_b128 v[100:103], v7 offset:25600
    ds_read_b128 v[32:35], v9
    ds_read_b128 v[36:39], v9 offset:512
    ds_read_b128 v[112:115], v9 offset:4096
    ds_read_b128 v[116:119], v9 offset:4608
    s_add_u32 m0, s10, 65536
    s_add_u32 s13, s97, 32768
    buffer_load_dwordx4 v126, s[56:59], s13 offen lds
    s_waitcnt lgkmcnt(8)
    v_mfma_f32_32x32x16_bf16 v[16:31], v[172:175], v[104:107], v[16:31]
    ds_read_b128 v[104:107], v7 offset:29696
    ds_read_b64_tr_b16 v[128:129], v124 offset:0
    ds_read_b64_tr_b16 v[130:131], v124 offset:256
    s_waitcnt lgkmcnt(10)
    v_mfma_f32_32x32x16_bf16 v[80:95], v[172:175], v[108:111], v[80:95]
    ds_read_b128 v[108:111], v7 offset:2048
    s_add_u32 m0, s10, 73728
    s_add_u32 s13, s97, 753664
    buffer_load_dwordx4 v126, s[56:59], s13 offen lds
    s_waitcnt lgkmcnt(10)
    v_mfma_f32_32x32x16_bf16 v[16:31], v[176:179], v[120:123], v[16:31]
    ds_read_b128 v[120:123], v7 offset:6144
    s_waitcnt lgkmcnt(5)
    s_nop 0
    ds_read_b64_tr_b16 v[132:133], v124 offset:8192
    ds_read_b64_tr_b16 v[134:135], v124 offset:8448
    s_waitcnt lgkmcnt(12)
    v_mfma_f32_32x32x16_bf16 v[16:31], v[180:183], v[96:99], v[16:31]
    ds_read_b128 v[96:99], v7 offset:10240
    v_mul_f32 v56, v64, v116
    v_mul_f32 v64, v64, v36
    v_fma_f32 v64, -v38, v40, v64
    v_fma_f32 v40, -v118, v40, v56
    s_add_u32 m0, s10, 81920
    s_add_u32 s13, s97, 49152
    buffer_load_dwordx4 v126, s[56:59], s13 offen lds
    s_waitcnt lgkmcnt(12)
    v_mfma_f32_32x32x16_bf16 v[16:31], v[184:187], v[100:103], v[16:31]
    ds_read_b128 v[100:103], v7 offset:14336
    v_mul_f32 v56, v65, v116
    v_mul_f32 v65, v65, v36
    v_fma_f32 v65, -v38, v41, v65
    v_fma_f32 v41, -v118, v41, v56
    ds_read_b64_tr_b16 v[136:137], v124 offset:16384
    ds_read_b64_tr_b16 v[138:139], v124 offset:16640
    s_waitcnt lgkmcnt(10)
    v_mfma_f32_32x32x16_bf16 v[16:31], v[188:191], v[104:107], v[16:31]
    ds_read_b128 v[104:107], v7 offset:18432
    v_mul_f32 v56, v66, v116
    v_mul_f32 v66, v66, v36
    v_fma_f32 v66, -v38, v42, v66
    v_fma_f32 v42, -v118, v42, v56
    s_add_u32 m0, s10, 90112
    s_add_u32 s13, s97, 770048
    buffer_load_dwordx4 v126, s[56:59], s13 offen lds
    s_waitcnt lgkmcnt(8)
    v_mfma_f32_32x32x16_bf16 v[16:31], v[192:195], v[108:111], v[16:31]
    ds_read_b128 v[108:111], v7 offset:22528
    v_mul_f32 v56, v67, v116
    v_mul_f32 v67, v67, v36
    v_fma_f32 v67, -v38, v43, v67
    v_fma_f32 v43, -v118, v43, v56
    ds_read_b64_tr_b16 v[140:141], v124 offset:24576
    ds_read_b64_tr_b16 v[142:143], v124 offset:24832
    s_waitcnt lgkmcnt(10)
    v_mfma_f32_32x32x16_bf16 v[16:31], v[196:199], v[120:123], v[16:31]
    ds_read_b128 v[120:123], v7 offset:26624
    v_mul_f32 v56, v68, v116
    v_mul_f32 v68, v68, v36
    v_fma_f32 v68, -v38, v44, v68
    v_fma_f32 v44, -v118, v44, v56
    s_add_u32 m0, s10, 147456
    s_add_u32 s13, s97, 65536
    buffer_load_dwordx4 v126, s[56:59], s13 offen lds
    s_waitcnt lgkmcnt(8)
    v_mfma_f32_32x32x16_bf16 v[16:31], v[200:203], v[96:99], v[16:31]
    ds_read_b128 v[96:99], v7 offset:30720
    v_mul_f32 v56, v69, v116
    v_mul_f32 v69, v69, v36
    v_fma_f32 v69, -v38, v45, v69
    v_fma_f32 v45, -v118, v45, v56
    s_waitcnt vmcnt(4)
    ds_read_b64_tr_b16 v[144:145], v127 offset:0
    ds_read_b64_tr_b16 v[146:147], v127 offset:256
    s_waitcnt lgkmcnt(10)
    v_mfma_f32_32x32x16_bf16 v[16:31], v[204:207], v[100:103], v[16:31]
    ds_read_b128 v[100:103], v7 offset:3072
    v_mul_f32 v56, v70, v116
    v_mul_f32 v70, v70, v36
    v_fma_f32 v70, -v38, v46, v70
    v_fma_f32 v46, -v118, v46, v56
    s_add_u32 m0, s10, 155648
    s_add_u32 s13, s97, 786432
    buffer_load_dwordx4 v126, s[56:59], s13 offen lds
    s_add_u32 m0, s10, 0
    s_add_u32 s13, s97, 81920
    buffer_load_dwordx4 v126, s[56:59], s13 offen lds
    s_waitcnt lgkmcnt(8)
    v_mfma_f32_32x32x16_bf16 v[16:31], v[208:211], v[104:107], v[16:31]
    ds_read_b128 v[104:107], v7 offset:7168
    v_mul_f32 v56, v71, v116
    v_mul_f32 v71, v71, v36
    v_fma_f32 v71, -v38, v47, v71
    v_fma_f32 v47, -v118, v47, v56
    s_waitcnt vmcnt(5)
    ds_read_b64_tr_b16 v[148:149], v127 offset:8192
    ds_read_b64_tr_b16 v[150:151], v127 offset:8448
    s_waitcnt lgkmcnt(10)
    v_mfma_f32_32x32x16_bf16 v[16:31], v[212:215], v[108:111], v[16:31]
    ds_read_b128 v[108:111], v7 offset:11264
    v_mul_f32 v56, v72, v116
    v_mul_f32 v72, v72, v36
    v_fma_f32 v72, -v38, v48, v72
    v_fma_f32 v48, -v118, v48, v56
    s_add_u32 m0, s10, 8192
    s_add_u32 s13, s97, 802816
    buffer_load_dwordx4 v126, s[56:59], s13 offen lds
    s_waitcnt lgkmcnt(8)
    v_mfma_f32_32x32x16_bf16 v[16:31], v[216:219], v[120:123], v[16:31]
    ds_read_b128 v[120:123], v7 offset:15360
    v_mul_f32 v56, v73, v116
    v_mul_f32 v73, v73, v36
    v_fma_f32 v73, -v38, v49, v73
    v_fma_f32 v49, -v118, v49, v56
    s_waitcnt vmcnt(5)
    ds_read_b64_tr_b16 v[152:153], v127 offset:16384
    ds_read_b64_tr_b16 v[154:155], v127 offset:16640
    s_waitcnt lgkmcnt(10)
    v_mfma_f32_32x32x16_bf16 v[16:31], v[220:223], v[96:99], v[16:31]
    ds_read_b128 v[96:99], v7 offset:19456
    v_mul_f32 v56, v74, v116
    v_mul_f32 v74, v74, v36
    v_fma_f32 v74, -v38, v50, v74
    v_fma_f32 v50, -v118, v50, v56
    s_add_u32 m0, s10, 16384
    s_add_u32 s13, s97, 98304
    buffer_load_dwordx4 v126, s[56:59], s13 offen lds
    s_waitcnt lgkmcnt(8)
    v_mfma_f32_32x32x16_bf16 v[16:31], v[224:227], v[100:103], v[16:31]
    ds_read_b128 v[100:103], v7 offset:23552
    v_mul_f32 v56, v75, v116
    v_mul_f32 v75, v75, v36
    v_fma_f32 v75, -v38, v51, v75
    v_fma_f32 v51, -v118, v51, v56
    s_waitcnt vmcnt(5)
    ds_read_b64_tr_b16 v[156:157], v127 offset:24576
    ds_read_b64_tr_b16 v[158:159], v127 offset:24832
    s_waitcnt lgkmcnt(10)
    v_mfma_f32_32x32x16_bf16 v[16:31], v[228:231], v[104:107], v[16:31]
    ds_read_b128 v[104:107], v7 offset:27648
    v_mul_f32 v56, v76, v116
    v_mul_f32 v76, v76, v36
    v_fma_f32 v76, -v38, v52, v76
    v_fma_f32 v52, -v118, v52, v56
    s_add_u32 m0, s10, 24576
    s_add_u32 s13, s97, 819200
    buffer_load_dwordx4 v126, s[56:59], s13 offen lds
    s_waitcnt lgkmcnt(8)
    v_mfma_f32_32x32x16_bf16 v[16:31], v[232:235], v[108:111], v[16:31]
    ds_read_b128 v[108:111], v7 offset:31744
    v_mul_f32 v56, v77, v116
    v_mul_f32 v77, v77, v36
    v_fma_f32 v77, -v38, v53, v77
    v_fma_f32 v53, -v118, v53, v56
    s_waitcnt vmcnt(5)
    ds_read_b64_tr_b16 v[160:161], v125 offset:0
    ds_read_b64_tr_b16 v[162:163], v125 offset:256
    s_waitcnt lgkmcnt(10)
    v_mfma_f32_32x32x16_bf16 v[16:31], v[236:239], v[120:123], v[16:31]
    ds_read_b128 v[120:123], v6 offset:17408
    v_mul_f32 v56, v78, v116
    v_mul_f32 v78, v78, v36
    v_fma_f32 v78, -v38, v54, v78
    v_fma_f32 v54, -v118, v54, v56
    s_add_u32 m0, s10, 65536
    s_add_u32 s13, s97, 114688
    buffer_load_dwordx4 v126, s[56:59], s13 offen lds
    s_waitcnt lgkmcnt(8)
    v_mfma_f32_32x32x16_bf16 v[16:31], v[240:243], v[96:99], v[16:31]
    ds_read_b128 v[96:99], v6 offset:21504
    v_mul_f32 v56, v79, v116
    v_mul_f32 v79, v79, v36
    v_fma_f32 v79, -v38, v55, v79
    v_fma_f32 v55, -v118, v55, v56
    s_waitcnt vmcnt(5)
    ds_read_b64_tr_b16 v[164:165], v125 offset:8192
    ds_read_b64_tr_b16 v[166:167], v125 offset:8448
    s_waitcnt lgkmcnt(10)
    v_mfma_f32_32x32x16_bf16 v[16:31], v[244:247], v[100:103], v[16:31]
    ds_read_b128 v[100:103], v6 offset:25600
    s_add_u32 m0, s10, 73728
    s_add_u32 s13, s97, 835584
    buffer_load_dwordx4 v126, s[56:59], s13 offen lds
    s_waitcnt lgkmcnt(8)
    v_mfma_f32_32x32x16_bf16 v[16:31], v[248:251], v[104:107], v[16:31]
    ds_read_b128 v[104:107], v6 offset:29696
    s_waitcnt lgkmcnt(8)
    v_mfma_f32_32x32x16_bf16 v[16:31], v[252:255], v[108:111], v[16:31]
    ds_read_b128 v[108:111], v6 offset:2048
    s_add_u32 m0, s10, 81920
    s_add_u32 s13, s97, 131072
    buffer_load_dwordx4 v126, s[56:59], s13 offen lds
    s_waitcnt lgkmcnt(6)
    v_mfma_f32_32x32x16_bf16 v[80:95], v[176:179], v[120:123], v[80:95]
    ds_read_b128 v[120:123], v6 offset:6144
    s_waitcnt lgkmcnt(6)
    v_mfma_f32_32x32x16_bf16 v[80:95], v[180:183], v[96:99], v[80:95]
    ds_read_b128 v[96:99], v6 offset:10240
    s_add_u32 m0, s10, 90112
    s_add_u32 s13, s97, 851968
    buffer_load_dwordx4 v126, s[56:59], s13 offen lds
    s_waitcnt lgkmcnt(4)
    v_mfma_f32_32x32x16_bf16 v[80:95], v[184:187], v[100:103], v[80:95]
    ds_read_b128 v[100:103], v6 offset:14336
    s_waitcnt lgkmcnt(4)
    v_mfma_f32_32x32x16_bf16 v[80:95], v[188:191], v[104:107], v[80:95]
    ds_read_b128 v[104:107], v6 offset:18432
    s_add_u32 m0, s10, 147456
    s_add_u32 s13, s97, 147456
    buffer_load_dwordx4 v126, s[56:59], s13 offen lds
    v_add_f32 v16, v16, v64
    v_add_f32 v17, v17, v65
    v_add_f32 v18, v18, v66
    v_add_f32 v19, v19, v67
    v_add_f32 v20, v20, v68
    v_add_f32 v21, v21, v69
    v_add_f32 v22, v22, v70
    v_add_f32 v23, v23, v71
    v_mul_f32 v56, v16, v16
    s_waitcnt lgkmcnt(4)
    v_mfma_f32_32x32x16_bf16 v[80:95], v[192:195], v[108:111], v[80:95]
    ds_read_b128 v[108:111], v6 offset:22528
    v_mul_f32 v57, v17, v17
    v_mul_f32 v58, v18, v18
    v_mul_f32 v59, v19, v19
    v_mul_f32 v60, v20, v20
    v_mul_f32 v61, v21, v21
    v_mul_f32 v62, v22, v22
    v_mul_f32 v63, v23, v23
    v_fma_f32 v56, v56, v32, v34
    v_fma_f32 v57, v57, v32, v34
    s_waitcnt lgkmcnt(4)
    v_mfma_f32_32x32x16_bf16 v[80:95], v[196:199], v[120:123], v[80:95]
    ds_read_b128 v[120:123], v6 offset:26624
    s_add_u32 m0, s10, 155648
    s_add_u32 s13, s97, 163840
    buffer_load_dwordx4 v126, s[56:59], s13 offen lds
    v_fma_f32 v58, v58, v32, v34
    v_fma_f32 v59, v59, v32, v34
    v_fma_f32 v60, v60, v32, v34
    v_fma_f32 v61, v61, v32, v34
    v_fma_f32 v62, v62, v32, v34
    v_fma_f32 v63, v63, v32, v34
    v_mul_f32 v56, v56, v16
    v_mul_f32 v57, v57, v17
    v_mul_f32 v58, v58, v18
    s_waitcnt lgkmcnt(4)
    v_mfma_f32_32x32x16_bf16 v[80:95], v[200:203], v[96:99], v[80:95]
    ds_read_b128 v[96:99], v6 offset:30720
    v_mul_f32 v59, v59, v19
    v_mul_f32 v60, v60, v20
    v_mul_f32 v61, v61, v21
    v_mul_f32 v62, v62, v22
    v_mul_f32 v63, v63, v23
    v_exp_f32 v56, v56
    v_exp_f32 v57, v57
    v_exp_f32 v58, v58
    v_exp_f32 v59, v59
    s_waitcnt lgkmcnt(4)
    v_mfma_f32_32x32x16_bf16 v[80:95], v[204:207], v[100:103], v[80:95]
    ds_read_b128 v[100:103], v6 offset:3072
    v_exp_f32 v60, v60
    v_exp_f32 v61, v61
    v_exp_f32 v62, v62
    v_exp_f32 v63, v63
    v_fma_f32 v56, v56, v36, v36
    v_fma_f32 v57, v57, v36, v36
    v_fma_f32 v58, v58, v36, v36
    v_fma_f32 v59, v59, v36, v36
    v_fma_f32 v60, v60, v36, v36
    s_waitcnt lgkmcnt(4)
    v_mfma_f32_32x32x16_bf16 v[80:95], v[208:211], v[104:107], v[80:95]
    ds_read_b128 v[104:107], v6 offset:7168
    v_fma_f32 v61, v61, v36, v36
    v_fma_f32 v62, v62, v36, v36
    v_fma_f32 v63, v63, v36, v36
    v_rcp_f32 v56, v56
    v_rcp_f32 v57, v57
    v_rcp_f32 v58, v58
    v_rcp_f32 v59, v59
    v_rcp_f32 v60, v60
    v_rcp_f32 v61, v61
    s_waitcnt lgkmcnt(4)
    v_mfma_f32_32x32x16_bf16 v[80:95], v[212:215], v[108:111], v[80:95]
    ds_read_b128 v[108:111], v6 offset:11264
    v_rcp_f32 v62, v62
    v_rcp_f32 v63, v63
    v_mul_f32 v16, v16, v56
    v_mul_f32 v17, v17, v57
    v_mul_f32 v18, v18, v58
    v_mul_f32 v19, v19, v59
    v_mul_f32 v20, v20, v60
    v_mul_f32 v21, v21, v61
    v_mul_f32 v22, v22, v62
    s_waitcnt lgkmcnt(4)
    v_mfma_f32_32x32x16_bf16 v[80:95], v[216:219], v[120:123], v[80:95]
    ds_read_b128 v[120:123], v6 offset:15360
    v_mul_f32 v23, v23, v63
    v_cvt_pk_bf16_f32 v56, v16, v17
    v_cvt_pk_bf16_f32 v57, v18, v19
    v_cvt_pk_bf16_f32 v58, v20, v21
    v_cvt_pk_bf16_f32 v59, v22, v23
    buffer_store_dwordx4 v[56:59], v3, s[52:55], s101 offen
    v_add_f32 v24, v24, v72
    v_add_f32 v25, v25, v73
    v_add_f32 v26, v26, v74
    s_waitcnt lgkmcnt(4)
    v_mfma_f32_32x32x16_bf16 v[80:95], v[220:223], v[96:99], v[80:95]
    ds_read_b128 v[96:99], v6 offset:19456
    v_add_f32 v27, v27, v75
    v_add_f32 v28, v28, v76
    v_add_f32 v29, v29, v77
    v_add_f32 v30, v30, v78
    v_add_f32 v31, v31, v79
    v_mul_f32 v64, v24, v24
    v_mul_f32 v65, v25, v25
    v_mul_f32 v66, v26, v26
    v_mul_f32 v67, v27, v27
    s_waitcnt lgkmcnt(4)
    v_mfma_f32_32x32x16_bf16 v[80:95], v[224:227], v[100:103], v[80:95]
    ds_read_b128 v[100:103], v6 offset:23552
    v_mul_f32 v68, v28, v28
    v_mul_f32 v69, v29, v29
    v_mul_f32 v70, v30, v30
    v_mul_f32 v71, v31, v31
    v_fma_f32 v64, v64, v32, v34
    v_fma_f32 v65, v65, v32, v34
    v_fma_f32 v66, v66, v32, v34
    v_fma_f32 v67, v67, v32, v34
    v_fma_f32 v68, v68, v32, v34
    s_waitcnt lgkmcnt(4)
    v_mfma_f32_32x32x16_bf16 v[80:95], v[228:231], v[104:107], v[80:95]
    ds_read_b128 v[104:107], v6 offset:27648
    v_fma_f32 v69, v69, v32, v34
    v_fma_f32 v70, v70, v32, v34
    v_fma_f32 v71, v71, v32, v34
    v_mul_f32 v64, v64, v24
    v_mul_f32 v65, v65, v25
    v_mul_f32 v66, v66, v26
    v_mul_f32 v67, v67, v27
    v_mul_f32 v68, v68, v28
    v_mul_f32 v69, v69, v29
    s_waitcnt lgkmcnt(4)
    v_mfma_f32_32x32x16_bf16 v[80:95], v[232:235], v[108:111], v[80:95]
    ds_read_b128 v[108:111], v6 offset:31744
    v_mul_f32 v70, v70, v30
    v_mul_f32 v71, v71, v31
    v_exp_f32 v64, v64
    v_exp_f32 v65, v65
    v_exp_f32 v66, v66
    v_exp_f32 v67, v67
    v_exp_f32 v68, v68
    v_exp_f32 v69, v69
    v_exp_f32 v70, v70
    s_waitcnt lgkmcnt(4)
    v_mfma_f32_32x32x16_bf16 v[80:95], v[236:239], v[120:123], v[80:95]
    v_exp_f32 v71, v71
    v_fma_f32 v64, v64, v36, v36
    v_fma_f32 v65, v65, v36, v36
    v_fma_f32 v66, v66, v36, v36
    v_fma_f32 v67, v67, v36, v36
    v_fma_f32 v68, v68, v36, v36
    v_fma_f32 v69, v69, v36, v36
    v_fma_f32 v70, v70, v36, v36
    v_fma_f32 v71, v71, v36, v36
    s_waitcnt lgkmcnt(3)
    v_mfma_f32_32x32x16_bf16 v[80:95], v[240:243], v[96:99], v[80:95]
    v_rcp_f32 v64, v64
    v_rcp_f32 v65, v65
    v_rcp_f32 v66, v66
    v_rcp_f32 v67, v67
    v_rcp_f32 v68, v68
    v_rcp_f32 v69, v69
    v_rcp_f32 v70, v70
    v_rcp_f32 v71, v71
    v_mul_f32 v24, v24, v64
    s_waitcnt lgkmcnt(2)
    v_mfma_f32_32x32x16_bf16 v[80:95], v[244:247], v[100:103], v[80:95]
    v_mul_f32 v25, v25, v65
    v_mul_f32 v26, v26, v66
    v_mul_f32 v27, v27, v67
    v_mul_f32 v28, v28, v68
    v_mul_f32 v29, v29, v69
    v_mul_f32 v30, v30, v70
    v_mul_f32 v31, v31, v71
    v_cvt_pk_bf16_f32 v64, v24, v25
    v_cvt_pk_bf16_f32 v65, v26, v27
    s_waitcnt lgkmcnt(1)
    v_mfma_f32_32x32x16_bf16 v[80:95], v[248:251], v[104:107], v[80:95]
    v_cvt_pk_bf16_f32 v66, v28, v29
    v_cvt_pk_bf16_f32 v67, v30, v31
    buffer_store_dwordx4 v[64:67], v3, s[52:55], s101 offen offset:1024
    s_waitcnt lgkmcnt(0)
    v_mfma_f32_32x32x16_bf16 v[80:95], v[252:255], v[108:111], v[80:95]
    s_waitcnt vmcnt(2)
    ds_read_b64_tr_b16 v[168:169], v124 offset:0
    ds_read_b64_tr_b16 v[170:171], v124 offset:256
    ds_read_b64_tr_b16 v[172:173], v124 offset:8192
    ds_read_b64_tr_b16 v[174:175], v124 offset:8448
    ds_read_b64_tr_b16 v[176:177], v124 offset:16384
    ds_read_b64_tr_b16 v[178:179], v124 offset:16640
    ds_read_b64_tr_b16 v[180:181], v124 offset:24576
    ds_read_b64_tr_b16 v[182:183], v124 offset:24832
    ds_read_b64_tr_b16 v[184:185], v127 offset:0
    ds_read_b64_tr_b16 v[186:187], v127 offset:256
    ds_read_b64_tr_b16 v[188:189], v127 offset:8192
    ds_read_b64_tr_b16 v[190:191], v127 offset:8448
    v_pk_add_f32 v[80:81], v[80:81], v[40:41]
    v_pk_add_f32 v[82:83], v[82:83], v[42:43]
    v_pk_add_f32 v[84:85], v[84:85], v[44:45]
    v_pk_add_f32 v[86:87], v[86:87], v[46:47]
    v_pk_add_f32 v[88:89], v[88:89], v[48:49]
    v_pk_add_f32 v[90:91], v[90:91], v[50:51]
    v_pk_add_f32 v[92:93], v[92:93], v[52:53]
    v_pk_add_f32 v[94:95], v[94:95], v[54:55]
    v_pk_mul_f32 v[16:17], v[80:81], v[80:81]
    v_pk_mul_f32 v[18:19], v[82:83], v[82:83]
    v_pk_mul_f32 v[20:21], v[84:85], v[84:85]
    v_pk_mul_f32 v[22:23], v[86:87], v[86:87]
    v_pk_mul_f32 v[24:25], v[88:89], v[88:89]
    v_pk_mul_f32 v[26:27], v[90:91], v[90:91]
    v_pk_mul_f32 v[28:29], v[92:93], v[92:93]
    v_pk_mul_f32 v[30:31], v[94:95], v[94:95]
    v_pk_fma_f32 v[16:17], v[16:17], v[112:113], v[114:115] op_sel_hi:[1,0,0]
    v_pk_fma_f32 v[18:19], v[18:19], v[112:113], v[114:115] op_sel_hi:[1,0,0]
    v_pk_fma_f32 v[20:21], v[20:21], v[112:113], v[114:115] op_sel_hi:[1,0,0]
    v_pk_fma_f32 v[22:23], v[22:23], v[112:113], v[114:115] op_sel_hi:[1,0,0]
    v_pk_fma_f32 v[24:25], v[24:25], v[112:113], v[114:115] op_sel_hi:[1,0,0]
    v_pk_fma_f32 v[26:27], v[26:27], v[112:113], v[114:115] op_sel_hi:[1,0,0]
    v_pk_fma_f32 v[28:29], v[28:29], v[112:113], v[114:115] op_sel_hi:[1,0,0]
    v_pk_fma_f32 v[30:31], v[30:31], v[112:113], v[114:115] op_sel_hi:[1,0,0]
    v_pk_mul_f32 v[16:17], v[16:17], v[80:81]
    v_pk_mul_f32 v[18:19], v[18:19], v[82:83]
    v_pk_mul_f32 v[20:21], v[20:21], v[84:85]
    v_pk_mul_f32 v[22:23], v[22:23], v[86:87]
    v_pk_mul_f32 v[24:25], v[24:25], v[88:89]
    v_pk_mul_f32 v[26:27], v[26:27], v[90:91]
    v_pk_mul_f32 v[28:29], v[28:29], v[92:93]
    v_pk_mul_f32 v[30:31], v[30:31], v[94:95]
    v_exp_f32 v16, v16
    v_exp_f32 v17, v17
    v_exp_f32 v18, v18
    v_exp_f32 v19, v19
    v_exp_f32 v20, v20
    v_exp_f32 v21, v21
    v_exp_f32 v22, v22
    v_exp_f32 v23, v23
    v_exp_f32 v24, v24
    v_exp_f32 v25, v25
    v_exp_f32 v26, v26
    v_exp_f32 v27, v27
    v_exp_f32 v28, v28
    v_exp_f32 v29, v29
    v_exp_f32 v30, v30
    v_exp_f32 v31, v31
    v_pk_fma_f32 v[16:17], v[16:17], v[116:117], v[116:117] op_sel_hi:[1,0,0]
    v_pk_fma_f32 v[18:19], v[18:19], v[116:117], v[116:117] op_sel_hi:[1,0,0]
    v_pk_fma_f32 v[20:21], v[20:21], v[116:117], v[116:117] op_sel_hi:[1,0,0]
    v_pk_fma_f32 v[22:23], v[22:23], v[116:117], v[116:117] op_sel_hi:[1,0,0]
    v_pk_fma_f32 v[24:25], v[24:25], v[116:117], v[116:117] op_sel_hi:[1,0,0]
    v_pk_fma_f32 v[26:27], v[26:27], v[116:117], v[116:117] op_sel_hi:[1,0,0]
    v_pk_fma_f32 v[28:29], v[28:29], v[116:117], v[116:117] op_sel_hi:[1,0,0]
    v_pk_fma_f32 v[30:31], v[30:31], v[116:117], v[116:117] op_sel_hi:[1,0,0]
    v_rcp_f32 v16, v16
    v_rcp_f32 v17, v17
    v_rcp_f32 v18, v18
    v_rcp_f32 v19, v19
    v_rcp_f32 v20, v20
    v_rcp_f32 v21, v21
    v_rcp_f32 v22, v22
    v_rcp_f32 v23, v23
    v_rcp_f32 v24, v24
    v_rcp_f32 v25, v25
    v_rcp_f32 v26, v26
    v_rcp_f32 v27, v27
    v_rcp_f32 v28, v28
    v_rcp_f32 v29, v29
    v_rcp_f32 v30, v30
    v_rcp_f32 v31, v31
    v_pk_mul_f32 v[80:81], v[80:81], v[16:17]
    v_pk_mul_f32 v[82:83], v[82:83], v[18:19]
    v_pk_mul_f32 v[84:85], v[84:85], v[20:21]
    v_pk_mul_f32 v[86:87], v[86:87], v[22:23]
    v_pk_mul_f32 v[88:89], v[88:89], v[24:25]
    v_pk_mul_f32 v[90:91], v[90:91], v[26:27]
    v_pk_mul_f32 v[92:93], v[92:93], v[28:29]
    v_pk_mul_f32 v[94:95], v[94:95], v[30:31]
    v_cvt_pk_bf16_f32 v16, v80, v81
    v_cvt_pk_bf16_f32 v17, v82, v83
    v_cvt_pk_bf16_f32 v18, v84, v85
    v_cvt_pk_bf16_f32 v19, v86, v87
    v_cvt_pk_bf16_f32 v20, v88, v89
    v_cvt_pk_bf16_f32 v21, v90, v91
    v_cvt_pk_bf16_f32 v22, v92, v93
    v_cvt_pk_bf16_f32 v23, v94, v95
    buffer_store_dwordx4 v[16:19], v3, s[52:55], s64 offen
    buffer_store_dwordx4 v[20:23], v3, s[52:55], s64 offen offset:1024
    ds_read_b64_tr_b16 v[192:193], v127 offset:16384
    ds_read_b64_tr_b16 v[194:195], v127 offset:16640
    ds_read_b64_tr_b16 v[196:197], v127 offset:24576
    ds_read_b64_tr_b16 v[198:199], v127 offset:24832
    ds_read_b64_tr_b16 v[200:201], v125 offset:0
    ds_read_b64_tr_b16 v[202:203], v125 offset:256
    ds_read_b64_tr_b16 v[204:205], v125 offset:8192
    ds_read_b64_tr_b16 v[206:207], v125 offset:8448
    s_branch L_f1_done
L_f1_s:
    s_setprio 1
    s_waitcnt vmcnt(4)
    s_barrier
    ds_read_b128 v[96:99], v7 offset:0
    ds_read_b128 v[100:103], v7 offset:4096
    ds_read_b128 v[104:107], v7 offset:8192
    ds_read_b128 v[108:111], v7 offset:12288
    ds_read_b128 v[112:115], v7 offset:16384
    s_add_u32 m0, s6, 32768
    s_add_u32 s13, s7, 8388608
    buffer_load_dwordx4 v3, s[52:55], s13 offen offset:2048 sc1 lds
    buffer_load_dwordx4 v3, s[52:55], s13 offen offset:3072 sc1 lds
    s_add_u32 m0, s6, 98304
    s_add_u32 s13, s7, 8421376
    buffer_load_dwordx4 v3, s[52:55], s13 offen offset:2048 sc1 lds
    buffer_load_dwordx4 v3, s[52:55], s13 offen offset:3072 sc1 lds
    s_waitcnt lgkmcnt(4)
    v_mfma_f32_32x32x16_bf16 v[16:31], v[128:131], v[96:99], 0
    ds_read_b128 v[96:99], v7 offset:20480
    s_waitcnt lgkmcnt(4)
    v_mfma_f32_32x32x16_bf16 v[16:31], v[132:135], v[100:103], v[16:31]
    ds_read_b128 v[100:103], v7 offset:24576
    s_waitcnt lgkmcnt(4)
    v_mfma_f32_32x32x16_bf16 v[16:31], v[136:139], v[104:107], v[16:31]
    ds_read_b128 v[104:107], v7 offset:28672
    s_waitcnt lgkmcnt(4)
    v_mfma_f32_32x32x16_bf16 v[16:31], v[140:143], v[108:111], v[16:31]
    s_waitcnt vmcnt(4)
    s_barrier
    ds_read_b128 v[108:111], v7 offset:1024
    ds_read2st64_b64 v[80:83], v8 offset0:0 offset1:1
    ds_read2st64_b64 v[84:87], v8 offset0:2 offset1:3
    ds_read2st64_b64 v[88:91], v8 offset0:4 offset1:5
    ds_read2st64_b64 v[92:95], v8 offset0:6 offset1:7
    s_waitcnt lgkmcnt(0)
    v_add_f32 v80, v80, v82
    v_add_f32 v81, v81, v83
    v_add_f32 v84, v84, v86
    v_add_f32 v85, v85, v87
    v_add_f32 v88, v88, v90
    v_add_f32 v89, v89, v91
    v_add_f32 v92, v92, v94
    v_add_f32 v93, v93, v95
    s_waitcnt lgkmcnt(8)
    v_mfma_f32_32x32x16_bf16 v[16:31], v[144:147], v[112:115], v[16:31]
    ds_read_b128 v[112:115], v7 offset:5120
    v_add_f32 v80, v80, v84
    v_add_f32 v81, v81, v85
    v_add_f32 v88, v88, v92
    v_add_f32 v89, v89, v93
    v_add_f32 v38, v80, v88
    v_add_f32 v39, v81, v89
    ds_read2st64_b64 v[80:83], v8 offset0:8 offset1:9
    ds_read2st64_b64 v[84:87], v8 offset0:10 offset1:11
    ds_read2st64_b64 v[88:91], v8 offset0:12 offset1:13
    ds_read2st64_b64 v[92:95], v8 offset0:14 offset1:15
    s_waitcnt lgkmcnt(12)
    v_mfma_f32_32x32x16_bf16 v[16:31], v[148:151], v[96:99], v[16:31]
    ds_read_b128 v[96:99], v7 offset:9216
    s_waitcnt lgkmcnt(1)
    v_add_f32 v80, v80, v82
    v_add_f32 v81, v81, v83
    v_add_f32 v84, v84, v86
    v_add_f32 v85, v85, v87
    v_add_f32 v88, v88, v90
    v_add_f32 v89, v89, v91
    v_add_f32 v92, v92, v94
    v_add_f32 v93, v93, v95
    s_waitcnt lgkmcnt(12)
    v_mfma_f32_32x32x16_bf16 v[16:31], v[152:155], v[100:103], v[16:31]
    ds_read_b128 v[100:103], v7 offset:13312
    v_add_f32 v80, v80, v84
    v_add_f32 v81, v81, v85
    v_add_f32 v88, v88, v92
    v_add_f32 v89, v89, v93
    v_add_f32 v80, v80, v88
    v_add_f32 v81, v81, v89
    v_add_f32 v38, v38, v80
    v_add_f32 v39, v39, v81
    v_mov_b32 v32, v38
    v_mov_b32 v33, v39
    s_waitcnt lgkmcnt(12)
    v_mfma_f32_32x32x16_bf16 v[16:31], v[156:159], v[104:107], v[16:31]
    ds_read_b128 v[104:107], v7 offset:17408
    s_nop 1
    v_permlane32_swap_b32 v38, v32
    v_permlane32_swap_b32 v39, v33
    s_nop 1
    v_add_f32 v38, v38, v32
    v_add_f32 v39, v39, v33
    v_mul_f32 v38, 0x3b000000, v38
    v_mul_f32 v39, 0x3b000000, v39
    v_fma_f32 v39, -v38, v38, v39
    v_max_f32 v39, 0, v39
    v_add_f32 v39, 0x3727c5ac, v39
    s_waitcnt lgkmcnt(12)
    v_mfma_f32_32x32x16_bf16 v[16:31], v[160:163], v[108:111], v[16:31]
    ds_read_b128 v[108:111], v7 offset:21504
    v_rsq_f32 v33, v39
    v_sqrt_f32 v36, v39
    v_mul_f32 v34, 0xc0135761, v33
    v_mul_f32 v35, v33, v33
    v_mul_f32 v35, 0x3d372713, v35
    v_mul_f32 v32, v34, v35
    s_waitcnt lgkmcnt(8)
    v_mfma_f32_32x32x16_bf16 v[16:31], v[164:167], v[112:115], v[16:31]
    ds_read_b128 v[112:115], v7 offset:25600
    ds_write_b128 v9, v[32:35]
    ds_write_b128 v9, v[36:39] offset:512
    s_waitcnt lgkmcnt(6)
    v_mfma_f32_32x32x16_bf16 v[16:31], v[168:171], v[96:99], v[16:31]
    ds_read_b128 v[96:99], v7 offset:29696
    s_waitcnt lgkmcnt(1)
    s_waitcnt lgkmcnt(6)
    v_mfma_f32_32x32x16_bf16 v[16:31], v[172:175], v[100:103], v[16:31]
    s_waitcnt vmcnt(0)
    s_barrier
    ds_read_b128 v[100:103], v7 offset:2048
    s_waitcnt lgkmcnt(6)
    v_mfma_f32_32x32x16_bf16 v[16:31], v[176:179], v[104:107], v[16:31]
    ds_read_b128 v[104:107], v7 offset:6144
    s_waitcnt lgkmcnt(6)
    v_mfma_f32_32x32x16_bf16 v[16:31], v[180:183], v[108:111], v[16:31]
    ds_read_b128 v[108:111], v7 offset:10240
    v_mul_f32 v64, v64, v36
    v_mul_f32 v65, v65, v36
    v_mul_f32 v66, v66, v36
    v_mul_f32 v67, v67, v36
    v_fma_f32 v64, -v38, v40, v64
    v_fma_f32 v65, -v38, v41, v65
    v_fma_f32 v66, -v38, v42, v66
    v_fma_f32 v67, -v38, v43, v67
    s_add_u32 m0, s10, 65536
    s_add_u32 s13, s97, 32768
    buffer_load_dwordx4 v126, s[56:59], s13 offen lds
    s_waitcnt lgkmcnt(6)
    v_mfma_f32_32x32x16_bf16 v[16:31], v[184:187], v[112:115], v[16:31]
    ds_read_b128 v[112:115], v7 offset:14336
    v_mul_f32 v68, v68, v36
    v_mul_f32 v69, v69, v36
    v_mul_f32 v70, v70, v36
    v_mul_f32 v71, v71, v36
    v_fma_f32 v68, -v38, v44, v68
    v_fma_f32 v69, -v38, v45, v69
    v_fma_f32 v70, -v38, v46, v70
    v_fma_f32 v71, -v38, v47, v71
    s_waitcnt lgkmcnt(4)
    v_mfma_f32_32x32x16_bf16 v[16:31], v[188:191], v[96:99], v[16:31]
    ds_read_b128 v[96:99], v7 offset:18432
    v_mul_f32 v72, v72, v36
    v_mul_f32 v73, v73, v36
    v_mul_f32 v74, v74, v36
    v_mul_f32 v75, v75, v36
    v_fma_f32 v72, -v38, v48, v72
    v_fma_f32 v73, -v38, v49, v73
    v_fma_f32 v74, -v38, v50, v74
    v_fma_f32 v75, -v38, v51, v75
    s_add_u32 m0, s10, 73728
    s_add_u32 s13, s97, 753664
    buffer_load_dwordx4 v126, s[56:59], s13 offen lds
    s_waitcnt lgkmcnt(4)
    v_mfma_f32_32x32x16_bf16 v[16:31], v[192:195], v[100:103], v[16:31]
    ds_read_b128 v[100:103], v7 offset:22528
    v_mul_f32 v76, v76, v36
    v_mul_f32 v77, v77, v36
    v_mul_f32 v78, v78, v36
    v_mul_f32 v79, v79, v36
    v_fma_f32 v76, -v38, v52, v76
    v_fma_f32 v77, -v38, v53, v77
    v_fma_f32 v78, -v38, v54, v78
    v_fma_f32 v79, -v38, v55, v79
    s_waitcnt lgkmcnt(4)
    v_mfma_f32_32x32x16_bf16 v[16:31], v[196:199], v[104:107], v[16:31]
    ds_read_b128 v[104:107], v7 offset:26624
    s_add_u32 m0, s10, 81920
    s_add_u32 s13, s97, 49152
    buffer_load_dwordx4 v126, s[56:59], s13 offen lds
    s_waitcnt lgkmcnt(4)
    v_mfma_f32_32x32x16_bf16 v[16:31], v[200:203], v[108:111], v[16:31]
    ds_read_b128 v[108:111], v7 offset:30720
    s_waitcnt lgkmcnt(4)
    v_mfma_f32_32x32x16_bf16 v[16:31], v[204:207], v[112:115], v[16:31]
    ds_read_b128 v[112:115], v7 offset:3072
    s_add_u32 m0, s10, 90112
    s_add_u32 s13, s97, 770048
    buffer_load_dwordx4 v126, s[56:59], s13 offen lds
    s_waitcnt lgkmcnt(4)
    v_mfma_f32_32x32x16_bf16 v[16:31], v[208:211], v[96:99], v[16:31]
    ds_read_b128 v[96:99], v7 offset:7168
    s_waitcnt lgkmcnt(4)
    v_mfma_f32_32x32x16_bf16 v[16:31], v[212:215], v[100:103], v[16:31]
    ds_read_b128 v[100:103], v7 offset:11264
    s_add_u32 m0, s10, 147456
    s_add_u32 s13, s97, 65536
    buffer_load_dwordx4 v126, s[56:59], s13 offen lds
    s_waitcnt lgkmcnt(4)
    v_mfma_f32_32x32x16_bf16 v[16:31], v[216:219], v[104:107], v[16:31]
    ds_read_b128 v[104:107], v7 offset:15360
    s_waitcnt lgkmcnt(4)
    v_mfma_f32_32x32x16_bf16 v[16:31], v[220:223], v[108:111], v[16:31]
    ds_read_b128 v[108:111], v7 offset:19456
    s_add_u32 m0, s10, 155648
    s_add_u32 s13, s97, 786432
    buffer_load_dwordx4 v126, s[56:59], s13 offen lds
    s_waitcnt lgkmcnt(4)
    v_mfma_f32_32x32x16_bf16 v[16:31], v[224:227], v[112:115], v[16:31]
    ds_read_b128 v[112:115], v7 offset:23552
    s_waitcnt lgkmcnt(4)
    v_mfma_f32_32x32x16_bf16 v[16:31], v[228:231], v[96:99], v[16:31]
    ds_read_b128 v[96:99], v7 offset:27648
    s_waitcnt lgkmcnt(4)
    v_mfma_f32_32x32x16_bf16 v[16:31], v[232:235], v[100:103], v[16:31]
    ds_read_b128 v[100:103], v7 offset:31744
    s_waitcnt lgkmcnt(4)
    v_mfma_f32_32x32x16_bf16 v[16:31], v[236:239], v[104:107], v[16:31]
    ds_read_b64_tr_b16 v[128:129], v124 offset:0
    ds_read_b64_tr_b16 v[130:131], v124 offset:256
    ds_read_b64_tr_b16 v[132:133], v124 offset:8192
    ds_read_b64_tr_b16 v[134:135], v124 offset:8448
    s_waitcnt lgkmcnt(7)
    v_mfma_f32_32x32x16_bf16 v[16:31], v[240:243], v[108:111], v[16:31]
    ds_read_b64_tr_b16 v[136:137], v124 offset:16384
    ds_read_b64_tr_b16 v[138:139], v124 offset:16640
    ds_read_b64_tr_b16 v[140:141], v124 offset:24576
    ds_read_b64_tr_b16 v[142:143], v124 offset:24832
    s_waitcnt lgkmcnt(10)
    v_mfma_f32_32x32x16_bf16 v[16:31], v[244:247], v[112:115], v[16:31]
    s_waitcnt vmcnt(4)
    ds_read_b64_tr_b16 v[144:145], v127 offset:0
    ds_read_b64_tr_b16 v[146:147], v127 offset:256
    ds_read_b64_tr_b16 v[148:149], v127 offset:8192
    ds_read_b64_tr_b16 v[150:151], v127 offset:8448
    s_waitcnt lgkmcnt(13)
    v_mfma_f32_32x32x16_bf16 v[16:31], v[248:251], v[96:99], v[16:31]
    s_waitcnt vmcnt(2)
    ds_read_b64_tr_b16 v[152:153], v127 offset:16384
    ds_read_b64_tr_b16 v[154:155], v127 offset:16640
    ds_read_b64_tr_b16 v[156:157], v127 offset:24576
    ds_read_b64_tr_b16 v[158:159], v127 offset:24832
    s_waitcnt lgkmcnt(15)
    v_mfma_f32_32x32x16_bf16 v[16:31], v[252:255], v[100:103], v[16:31]
    s_waitcnt vmcnt(0)
    ds_read_b64_tr_b16 v[160:161], v125 offset:0
    ds_read_b64_tr_b16 v[162:163], v125 offset:256
    ds_read_b64_tr_b16 v[164:165], v125 offset:8192
    ds_read_b64_tr_b16 v[166:167], v125 offset:8448
    s_setprio 0
    s_waitcnt lgkmcnt(0)
    s_cmp_eq_u32 s67, 0x400000
    s_cbranch_scc1 L_f1_g
    s_nop 5
    s_add_u32 m0, s10, 0
    s_add_u32 s13, s97, 81920
    buffer_load_dwordx4 v126, s[56:59], s13 offen lds
    v_add_f32 v16, v16, v64
    v_add_f32 v17, v17, v65
    v_add_f32 v18, v18, v66
    v_add_f32 v19, v19, v67
    v_add_f32 v20, v20, v68
    v_add_f32 v21, v21, v69
    v_add_f32 v22, v22, v70
    v_add_f32 v23, v23, v71
    v_add_f32 v24, v24, v72
    v_add_f32 v25, v25, v73
    v_add_f32 v26, v26, v74
    v_add_f32 v27, v27, v75
    s_add_u32 m0, s10, 8192
    s_add_u32 s13, s97, 802816
    buffer_load_dwordx4 v126, s[56:59], s13 offen lds
    v_add_f32 v28, v28, v76
    v_add_f32 v29, v29, v77
    v_add_f32 v30, v30, v78
    v_add_f32 v31, v31, v79
    v_mul_f32 v40, v16, v16
    v_mul_f32 v41, v17, v17
    v_mul_f32 v42, v18, v18
    v_mul_f32 v43, v19, v19
    v_mul_f32 v44, v20, v20
    v_mul_f32 v45, v21, v21
    v_mul_f32 v46, v22, v22
    v_mul_f32 v47, v23, v23
    s_add_u32 m0, s10, 16384
    s_add_u32 s13, s97, 98304
    buffer_load_dwordx4 v126, s[56:59], s13 offen lds
    v_mul_f32 v48, v24, v24
    v_mul_f32 v49, v25, v25
    v_mul_f32 v50, v26, v26
    v_mul_f32 v51, v27, v27
    v_mul_f32 v52, v28, v28
    v_mul_f32 v53, v29, v29
    v_mul_f32 v54, v30, v30
    v_mul_f32 v55, v31, v31
    v_fma_f32 v40, v40, v32, v34
    v_fma_f32 v41, v41, v32, v34
    v_fma_f32 v42, v42, v32, v34
    v_fma_f32 v43, v43, v32, v34
    s_add_u32 m0, s10, 24576
    s_add_u32 s13, s97, 819200
    buffer_load_dwordx4 v126, s[56:59], s13 offen lds
    v_fma_f32 v44, v44, v32, v34
    v_fma_f32 v45, v45, v32, v34
    v_fma_f32 v46, v46, v32, v34
    v_fma_f32 v47, v47, v32, v34
    v_fma_f32 v48, v48, v32, v34
    v_fma_f32 v49, v49, v32, v34
    v_fma_f32 v50, v50, v32, v34
    v_fma_f32 v51, v51, v32, v34
    v_fma_f32 v52, v52, v32, v34
    v_fma_f32 v53, v53, v32, v34
    v_fma_f32 v54, v54, v32, v34
    v_fma_f32 v55, v55, v32, v34
    s_add_u32 m0, s10, 65536
    s_add_u32 s13, s97, 114688
    buffer_load_dwordx4 v126, s[56:59], s13 offen lds
    v_mul_f32 v40, v40, v16
    v_mul_f32 v41, v41, v17
    v_mul_f32 v42, v42, v18
    v_mul_f32 v43, v43, v19
    v_mul_f32 v44, v44, v20
    v_mul_f32 v45, v45, v21
    v_mul_f32 v46, v46, v22
    v_mul_f32 v47, v47, v23
    v_mul_f32 v48, v48, v24
    v_mul_f32 v49, v49, v25
    v_mul_f32 v50, v50, v26
    v_mul_f32 v51, v51, v27
    s_add_u32 m0, s10, 73728
    s_add_u32 s13, s97, 835584
    buffer_load_dwordx4 v126, s[56:59], s13 offen lds
    v_mul_f32 v52, v52, v28
    v_mul_f32 v53, v53, v29
    v_mul_f32 v54, v54, v30
    v_mul_f32 v55, v55, v31
    v_exp_f32 v40, v40
    v_exp_f32 v41, v41
    v_exp_f32 v42, v42
    v_exp_f32 v43, v43
    v_exp_f32 v44, v44
    v_exp_f32 v45, v45
    v_exp_f32 v46, v46
    v_exp_f32 v47, v47
    s_add_u32 m0, s10, 81920
    s_add_u32 s13, s97, 131072
    buffer_load_dwordx4 v126, s[56:59], s13 offen lds
    v_exp_f32 v48, v48
    v_exp_f32 v49, v49
    v_exp_f32 v50, v50
    v_exp_f32 v51, v51
    v_exp_f32 v52, v52
    v_exp_f32 v53, v53
    v_exp_f32 v54, v54
    v_exp_f32 v55, v55
    v_fma_f32 v40, v40, v36, v36
    v_fma_f32 v41, v41, v36, v36
    v_fma_f32 v42, v42, v36, v36
    v_fma_f32 v43, v43, v36, v36
    s_add_u32 m0, s10, 90112
    s_add_u32 s13, s97, 851968
    buffer_load_dwordx4 v126, s[56:59], s13 offen lds
    v_fma_f32 v44, v44, v36, v36
    v_fma_f32 v45, v45, v36, v36
    v_fma_f32 v46, v46, v36, v36
    v_fma_f32 v47, v47, v36, v36
    v_fma_f32 v48, v48, v36, v36
    v_fma_f32 v49, v49, v36, v36
    v_fma_f32 v50, v50, v36, v36
    v_fma_f32 v51, v51, v36, v36
    v_fma_f32 v52, v52, v36, v36
    v_fma_f32 v53, v53, v36, v36
    v_fma_f32 v54, v54, v36, v36
    v_fma_f32 v55, v55, v36, v36
    s_add_u32 m0, s10, 147456
    s_add_u32 s13, s97, 147456
    buffer_load_dwordx4 v126, s[56:59], s13 offen lds
    v_rcp_f32 v40, v40
    v_rcp_f32 v41, v41
    v_rcp_f32 v42, v42
    v_rcp_f32 v43, v43
    v_rcp_f32 v44, v44
    v_rcp_f32 v45, v45
    v_rcp_f32 v46, v46
    v_rcp_f32 v47, v47
    v_rcp_f32 v48, v48
    v_rcp_f32 v49, v49
    v_rcp_f32 v50, v50
    v_rcp_f32 v51, v51
    s_add_u32 m0, s10, 155648
    s_add_u32 s13, s97, 163840
    buffer_load_dwordx4 v126, s[56:59], s13 offen lds
    v_rcp_f32 v52, v52
    v_rcp_f32 v53, v53
    v_rcp_f32 v54, v54
    v_rcp_f32 v55, v55
    v_mul_f32 v16, v16, v40
    v_mul_f32 v17, v17, v41
    v_mul_f32 v18, v18, v42
    v_mul_f32 v19, v19, v43
    v_mul_f32 v20, v20, v44
    v_mul_f32 v21, v21, v45
    v_mul_f32 v22, v22, v46
    v_mul_f32 v23, v23, v47
    v_mul_f32 v24, v24, v48
    v_mul_f32 v25, v25, v49
    v_mul_f32 v26, v26, v50
    v_mul_f32 v27, v27, v51
    v_mul_f32 v28, v28, v52
    v_mul_f32 v29, v29, v53
    v_mul_f32 v30, v30, v54
    v_mul_f32 v31, v31, v55
    v_cvt_pk_bf16_f32 v40, v16, v17
    v_cvt_pk_bf16_f32 v41, v18, v19
    v_cvt_pk_bf16_f32 v42, v20, v21
    v_cvt_pk_bf16_f32 v43, v22, v23
    v_cvt_pk_bf16_f32 v44, v24, v25
    v_cvt_pk_bf16_f32 v45, v26, v27
    v_cvt_pk_bf16_f32 v46, v28, v29
    v_cvt_pk_bf16_f32 v47, v30, v31
    s_mov_b32 s13, s101
    buffer_store_dwordx4 v[40:43], v3, s[52:55], s13 offen
    buffer_store_dwordx4 v[44:47], v3, s[52:55], s13 offen offset:1024
L_f1_gr:
    s_waitcnt vmcnt(2)
    ds_read_b64_tr_b16 v[168:169], v124 offset:0
    ds_read_b64_tr_b16 v[170:171], v124 offset:256
    ds_read_b64_tr_b16 v[172:173], v124 offset:8192
    ds_read_b64_tr_b16 v[174:175], v124 offset:8448
    ds_read_b64_tr_b16 v[176:177], v124 offset:16384
    ds_read_b64_tr_b16 v[178:179], v124 offset:16640
    ds_read_b64_tr_b16 v[180:181], v124 offset:24576
    ds_read_b64_tr_b16 v[182:183], v124 offset:24832
    ds_read_b64_tr_b16 v[184:185], v127 offset:0
    ds_read_b64_tr_b16 v[186:187], v127 offset:256
    ds_read_b64_tr_b16 v[188:189], v127 offset:8192
    ds_read_b64_tr_b16 v[190:191], v127 offset:8448
    ds_read_b64_tr_b16 v[192:193], v127 offset:16384
    ds_read_b64_tr_b16 v[194:195], v127 offset:16640
    ds_read_b64_tr_b16 v[196:197], v127 offset:24576
    ds_read_b64_tr_b16 v[198:199], v127 offset:24832
    ds_read_b64_tr_b16 v[200:201], v125 offset:0
    ds_read_b64_tr_b16 v[202:203], v125 offset:256
    ds_read_b64_tr_b16 v[204:205], v125 offset:8192
    ds_read_b64_tr_b16 v[206:207], v125 offset:8448
L_f1_done:
    v_mov_b32 v4, 1
    s_cmp_eq_u32 s42, 0
    s_waitcnt vmcnt(0) lgkmcnt(0)
    s_mov_b64 exec, 1
    s_cbranch_scc0 L_x3_slow
    buffer_store_dword v4, v5, s[52:55], s24 offen offset:96
L_x3_set:
    s_mov_b64 exec, s[18:19]
    buffer_load_dword v4, v5, s[52:55], s68 offen offset:96 sc1
    s_mov_b64 exec, -1
    buffer_load_dwordx4 v[48:51], v11, s[88:91], s17 offen
    s_add_u32 m0, s10, 65536
    s_add_u32 s14, s97, 868352
    buffer_load_dwordx4 v126, s[56:59], s14 offen lds
    s_add_u32 m0, s10, 73728
    s_add_u32 s14, s97, 884736
    buffer_load_dwordx4 v126, s[56:59], s14 offen lds
    v_add_u32 v52, s16, v3
    v_xor_b32 v60, 0x2000, v52
    v_add_u32 v53, 0x10000, v52
    v_add_u32 v61, 0x10000, v60
    v_add_u32 v54, 0x20000, v52
    v_add_u32 v62, 0x20000, v60
    s_mul_i32 s13, s3, 6144
    s_add_u32 s13, s13, 16384
    v_add_u32 v6, s13, v3
    s_xor_b32 s14, s3, 2
    s_mul_i32 s14, s14, 6144
    s_add_u32 s14, s14, 16384
    v_add_u32 v7, s14, v3
    s_xor_b32 s14, s3, 4
    s_mul_i32 s14, s14, 6144
    s_add_u32 s14, s14, 18432
    v_add_u32 v8, s14, v3
    s_xor_b32 s14, s3, 6
    s_mul_i32 s14, s14, 6144
    s_add_u32 s14, s14, 20480
    v_add_u32 v9, s14, v3
    s_barrier
    s_mov_b64 exec, s[18:19]
    s_mov_b32 s13, 0
    s_waitcnt vmcnt(0)
    v_cmp_eq_u32 vcc, 0, v4
    s_cbranch_vccz L_x3_out
    buffer_load_dword v4, v5, s[52:55], s68 offen offset:96 sc1
L_x3_poll:
    buffer_load_dword v2, v5, s[52:55], s68 offen offset:96 sc1
    s_waitcnt vmcnt(1)
    v_cmp_eq_u32 vcc, 0, v4
    s_cbranch_vccz L_x3_out
    buffer_load_dword v4, v5, s[52:55], s68 offen offset:96 sc1
    s_waitcnt vmcnt(1)
    v_cmp_eq_u32 vcc, 0, v2
    s_cbranch_vccz L_x3_out
    s_add_u32 s13, s13, 1
    s_cmp_lt_u32 s13, 1048576
    s_cbranch_scc1 L_x3_poll
L_x3_out:
    s_mov_b64 exec, -1
    s_cmp_eq_u32 s42, 0
    s_cbranch_scc0 L_x3_inv
L_x3_go:
    s_add_u32 m0, s10, 0
    s_add_u32 s13, s28, 0
    buffer_load_dwordx4 v3, s[52:55], s13 offen sc1 lds
    s_add_u32 m0, s10, 8192
    s_add_u32 s13, s28, 88064
    buffer_load_dwordx4 v3, s[52:55], s13 offen sc1 lds
    s_barrier
    s_add_u32 m0, s10, 16384
    s_add_u32 s13, s28, 1024
    buffer_load_dwordx4 v3, s[52:55], s13 offen sc1 lds
    s_add_u32 m0, s10, 24576
    s_add_u32 s13, s28, 89088
    buffer_load_dwordx4 v3, s[52:55], s13 offen sc1 lds
    s_add_u32 m0, s10, 32768
    s_add_u32 s13, s28, 2048
    buffer_load_dwordx4 v3, s[52:55], s13 offen sc1 lds
    s_add_u32 m0, s10, 40960
    s_add_u32 s13, s28, 90112
    buffer_load_dwordx4 v3, s[52:55], s13 offen sc1 lds
    s_add_u32 m0, s10, 49152
    s_add_u32 s13, s28, 3072
    buffer_load_dwordx4 v3, s[52:55], s13 offen sc1 lds
    s_add_u32 m0, s10, 57344
    s_add_u32 s13, s28, 91136
    buffer_load_dwordx4 v3, s[52:55], s13 offen sc1 lds
    ds_read_b64_tr_b16 v[208:209], v127 offset:0
    ds_read_b64_tr_b16 v[210:211], v127 offset:256
    ds_read_b64_tr_b16 v[212:213], v127 offset:8192
    ds_read_b64_tr_b16 v[214:215], v127 offset:8448
    v_lshlrev_b32 v16, 16, v12
    v_and_b32 v17, 0xffff0000, v12
    v_lshlrev_b32 v24, 16, v48
    v_and_b32 v25, 0xffff0000, v48
    v_lshlrev_b32 v18, 16, v13
    v_and_b32 v19, 0xffff0000, v13
    v_lshlrev_b32 v26, 16, v49
    v_and_b32 v27, 0xffff0000, v49
    v_lshlrev_b32 v20, 16, v14
    v_and_b32 v21, 0xffff0000, v14
    v_lshlrev_b32 v28, 16, v50
    v_and_b32 v29, 0xffff0000, v50
    v_lshlrev_b32 v22, 16, v15
    v_and_b32 v23, 0xffff0000, v15
    v_lshlrev_b32 v30, 16, v51
    v_and_b32 v31, 0xffff0000, v51
    v_pk_add_f32 v[16:17], v[16:17], v[24:25]
    v_pk_add_f32 v[18:19], v[18:19], v[26:27]
    v_pk_add_f32 v[20:21], v[20:21], v[28:29]
    v_pk_add_f32 v[22:23], v[22:23], v[30:31]
    v_mov_b64 v[24:25], 0
    v_mov_b64 v[26:27], 0
    v_mov_b64 v[28:29], 0
    v_mov_b64 v[30:31], 0
    s_waitcnt lgkmcnt(0)
    s_waitcnt vmcnt(6)
    s_barrier
    ds_read_b128 v[64:67], v52 offset:0
    ds_read_b128 v[68:71], v60 offset:0
    ds_read_b128 v[72:75], v52 offset:4096
    ds_read_b128 v[76:79], v60 offset:4096
    s_add_u32 m0, s10, 65536
    s_add_u32 s13, s28, 4096
    buffer_load_dwordx4 v3, s[52:55], s13 offen sc1 lds
    s_add_u32 m0, s10, 73728
    s_add_u32 s13, s28, 92160
    buffer_load_dwordx4 v3, s[52:55], s13 offen sc1 lds
    s_waitcnt lgkmcnt(3)
    v_mfma_f32_32x32x16_bf16 v[16:31], v[128:131], v[64:67], v[16:31]
    s_waitcnt lgkmcnt(2)
    v_mfma_f32_32x32x16_bf16 v[32:47], v[128:131], v[68:71], 0
    s_waitcnt vmcnt(6)
    s_barrier
    ds_read_b128 v[64:67], v52 offset:16384
    ds_read_b128 v[68:71], v60 offset:16384
    s_add_u32 m0, s10, 81920
    s_add_u32 s13, s28, 5120
    buffer_load_dwordx4 v3, s[52:55], s13 offen sc1 lds
    s_add_u32 m0, s10, 90112
    s_add_u32 s13, s28, 93184
    buffer_load_dwordx4 v3, s[52:55], s13 offen sc1 lds
    s_waitcnt lgkmcnt(3)
    v_mfma_f32_32x32x16_bf16 v[16:31], v[132:135], v[72:75], v[16:31]
    s_waitcnt lgkmcnt(2)
    v_mfma_f32_32x32x16_bf16 v[32:47], v[132:135], v[76:79], v[32:47]
    ds_read_b128 v[72:75], v52 offset:20480
    ds_read_b128 v[76:79], v60 offset:20480
    s_waitcnt lgkmcnt(3)
    v_mfma_f32_32x32x16_bf16 v[16:31], v[136:139], v[64:67], v[16:31]
    s_waitcnt lgkmcnt(2)
    v_mfma_f32_32x32x16_bf16 v[32:47], v[136:139], v[68:71], v[32:47]
    s_waitcnt vmcnt(6)
    s_barrier
    ds_read_b128 v[64:67], v52 offset:32768
    ds_read_b128 v[68:71], v60 offset:32768
    s_add_u32 m0, s10, 98304
    s_add_u32 s13, s28, 6144
    buffer_load_dwordx4 v3, s[52:55], s13 offen sc1 lds
    s_add_u32 m0, s10, 106496
    s_add_u32 s13, s28, 94208
    buffer_load_dwordx4 v3, s[52:55], s13 offen sc1 lds
    s_waitcnt lgkmcnt(3)
    v_mfma_f32_32x32x16_bf16 v[16:31], v[140:143], v[72:75], v[16:31]
    s_waitcnt lgkmcnt(2)
    v_mfma_f32_32x32x16_bf16 v[32:47], v[140:143], v[76:79], v[32:47]
    ds_read_b128 v[72:75], v52 offset:36864
    ds_read_b128 v[76:79], v60 offset:36864
    s_waitcnt lgkmcnt(3)
    v_mfma_f32_32x32x16_bf16 v[16:31], v[144:147], v[64:67], v[16:31]
    s_waitcnt lgkmcnt(2)
    v_mfma_f32_32x32x16_bf16 v[32:47], v[144:147], v[68:71], v[32:47]
    s_waitcnt vmcnt(6)
    s_barrier
    ds_read_b128 v[64:67], v52 offset:49152
    ds_read_b128 v[68:71], v60 offset:49152
    s_add_u32 m0, s10, 114688
    s_add_u32 s13, s28, 7168
    buffer_load_dwordx4 v3, s[52:55], s13 offen sc1 lds
    s_add_u32 m0, s10, 122880
    s_add_u32 s13, s28, 95232
    buffer_load_dwordx4 v3, s[52:55], s13 offen sc1 lds
    s_waitcnt lgkmcnt(3)
    v_mfma_f32_32x32x16_bf16 v[16:31], v[148:151], v[72:75], v[16:31]
    s_waitcnt lgkmcnt(2)
    v_mfma_f32_32x32x16_bf16 v[32:47], v[148:151], v[76:79], v[32:47]
    ds_read_b128 v[72:75], v52 offset:53248
    ds_read_b128 v[76:79], v60 offset:53248
    s_waitcnt lgkmcnt(3)
    v_mfma_f32_32x32x16_bf16 v[16:31], v[152:155], v[64:67], v[16:31]
    s_waitcnt lgkmcnt(2)
    v_mfma_f32_32x32x16_bf16 v[32:47], v[152:155], v[68:71], v[32:47]
    s_waitcnt vmcnt(6)
    s_barrier
    ds_read_b128 v[64:67], v53 offset:0
    ds_read_b128 v[68:71], v61 offset:0
    s_add_u32 m0, s10, 131072
    s_add_u32 s13, s28, 8192
    buffer_load_dwordx4 v3, s[52:55], s13 offen sc1 lds
    s_add_u32 m0, s10, 139264
    s_add_u32 s13, s28, 96256
    buffer_load_dwordx4 v3, s[52:55], s13 offen sc1 lds
    s_waitcnt lgkmcnt(3)
    v_mfma_f32_32x32x16_bf16 v[16:31], v[156:159], v[72:75], v[16:31]
    s_waitcnt lgkmcnt(2)
    v_mfma_f32_32x32x16_bf16 v[32:47], v[156:159], v[76:79], v[32:47]
    ds_read_b128 v[72:75], v53 offset:4096
    ds_read_b128 v[76:79], v61 offset:4096
    s_waitcnt lgkmcnt(3)
    v_mfma_f32_32x32x16_bf16 v[16:31], v[160:163], v[64:67], v[16:31]
    s_waitcnt lgkmcnt(2)
    v_mfma_f32_32x32x16_bf16 v[32:47], v[160:163], v[68:71], v[32:47]
    s_waitcnt vmcnt(6)
    s_barrier
    ds_read_b128 v[64:67], v53 offset:16384
    ds_read_b128 v[68:71], v61 offset:16384
    s_add_u32 m0, s10, 147456
    s_add_u32 s13, s28, 9216
    buffer_load_dwordx4 v3, s[52:55], s13 offen sc1 lds
    s_add_u32 m0, s10, 155648
    s_add_u32 s13, s28, 97280
    buffer_load_dwordx4 v3, s[52:55], s13 offen sc1 lds
    s_waitcnt lgkmcnt(3)
    v_mfma_f32_32x32x16_bf16 v[16:31], v[164:167], v[72:75], v[16:31]
    s_waitcnt lgkmcnt(2)
    v_mfma_f32_32x32x16_bf16 v[32:47], v[164:167], v[76:79], v[32:47]
    ds_read_b128 v[72:75], v53 offset:20480
    ds_read_b128 v[76:79], v61 offset:20480
    s_waitcnt lgkmcnt(3)
    v_mfma_f32_32x32x16_bf16 v[16:31], v[168:171], v[64:67], v[16:31]
    s_waitcnt lgkmcnt(2)
    v_mfma_f32_32x32x16_bf16 v[32:47], v[168:171], v[68:71], v[32:47]
    s_waitcnt vmcnt(6)
    s_barrier
    ds_read_b128 v[64:67], v53 offset:32768
    ds_read_b128 v[68:71], v61 offset:32768
    s_add_u32 m0, s10, 0
    s_add_u32 s13, s28, 10240
    buffer_load_dwordx4 v3, s[52:55], s13 offen sc1 lds
    s_add_u32 m0, s10, 8192
    s_add_u32 s13, s28, 98304
    buffer_load_dwordx4 v3, s[52:55], s13 offen sc1 lds
    s_waitcnt lgkmcnt(3)
    v_mfma_f32_32x32x16_bf16 v[16:31], v[172:175], v[72:75], v[16:31]
    s_waitcnt lgkmcnt(2)
    v_mfma_f32_32x32x16_bf16 v[32:47], v[172:175], v[76:79], v[32:47]
    ds_read_b128 v[72:75], v53 offset:36864
    ds_read_b128 v[76:79], v61 offset:36864
    s_waitcnt lgkmcnt(3)
    v_mfma_f32_32x32x16_bf16 v[16:31], v[176:179], v[64:67], v[16:31]
    s_waitcnt lgkmcnt(2)
    v_mfma_f32_32x32x16_bf16 v[32:47], v[176:179], v[68:71], v[32:47]
    s_waitcnt vmcnt(6)
    s_barrier
    ds_read_b128 v[64:67], v53 offset:49152
    ds_read_b128 v[68:71], v61 offset:49152
    s_waitcnt lgkmcnt(3)
    v_mfma_f32_32x32x16_bf16 v[16:31], v[180:183], v[72:75], v[16:31]
    s_waitcnt lgkmcnt(2)
    v_mfma_f32_32x32x16_bf16 v[32:47], v[180:183], v[76:79], v[32:47]
    ds_read_b128 v[72:75], v53 offset:53248
    ds_read_b128 v[76:79], v61 offset:53248
    s_waitcnt lgkmcnt(3)
    v_mfma_f32_32x32x16_bf16 v[16:31], v[184:187], v[64:67], v[16:31]
    s_waitcnt lgkmcnt(2)
    v_mfma_f32_32x32x16_bf16 v[32:47], v[184:187], v[68:71], v[32:47]
    s_waitcnt vmcnt(4)
    s_barrier
    ds_read_b128 v[64:67], v54 offset:0
    ds_read_b128 v[68:71], v62 offset:0
    s_cmp_eq_u32 s3, 7
    s_cbranch_scc0 L_wb
    s_cmp_lt_u32 s2, 8
    s_cbranch_scc0 L_wb
    buffer_wbl2 sc1
L_wb:
    s_waitcnt lgkmcnt(3)
    v_mfma_f32_32x32x16_bf16 v[16:31], v[188:191], v[72:75], v[16:31]
    s_waitcnt lgkmcnt(2)
    v_mfma_f32_32x32x16_bf16 v[32:47], v[188:191], v[76:79], v[32:47]
    ds_read_b128 v[72:75], v54 offset:4096
    ds_read_b128 v[76:79], v62 offset:4096
    s_waitcnt lgkmcnt(3)
    v_mfma_f32_32x32x16_bf16 v[16:31], v[192:195], v[64:67], v[16:31]
    s_waitcnt lgkmcnt(2)
    v_mfma_f32_32x32x16_bf16 v[32:47], v[192:195], v[68:71], v[32:47]
    s_cmp_eq_u32 s3, 7
    s_cbranch_scc1 L_nwf9
    s_waitcnt vmcnt(2)
L_nwf9:
    s_barrier
    ds_read_b128 v[64:67], v54 offset:16384
    ds_read_b128 v[68:71], v62 offset:16384
    s_waitcnt lgkmcnt(3)
    v_mfma_f32_32x32x16_bf16 v[16:31], v[196:199], v[72:75], v[16:31]
    s_waitcnt lgkmcnt(2)
    v_mfma_f32_32x32x16_bf16 v[32:47], v[196:199], v[76:79], v[32:47]
    s_cmp_eq_u32 s3, 7
    s_cbranch_scc1 L_nwf10
    s_waitcnt vmcnt(0)
L_nwf10:
    s_barrier
    ds_read_b128 v[72:75], v52 offset:0
    ds_read_b128 v[76:79], v60 offset:0
    s_waitcnt lgkmcnt(3)
    v_mfma_f32_32x32x16_bf16 v[16:31], v[200:203], v[64:67], v[16:31]
    s_waitcnt lgkmcnt(2)
    v_mfma_f32_32x32x16_bf16 v[32:47], v[200:203], v[68:71], v[32:47]
    ds_read_b128 v[64:67], v54 offset:20480
    ds_read_b128 v[68:71], v62 offset:20480
    s_waitcnt lgkmcnt(3)
    v_mfma_f32_32x32x16_bf16 v[16:31], v[204:207], v[72:75], v[16:31]
    s_waitcnt lgkmcnt(2)
    v_mfma_f32_32x32x16_bf16 v[32:47], v[204:207], v[76:79], v[32:47]
    ds_read_b128 v[72:75], v52 offset:4096
    ds_read_b128 v[76:79], v60 offset:4096
    s_cmp_eq_u32 s98, 3
    s_cbranch_scc1 L_f2_skip
    s_waitcnt lgkmcnt(3)
    v_mfma_f32_32x32x16_bf16 v[16:31], v[208:211], v[64:67], v[16:31]
    s_waitcnt lgkmcnt(2)
    v_mfma_f32_32x32x16_bf16 v[32:47], v[208:211], v[68:71], v[32:47]
    s_waitcnt lgkmcnt(1)
    v_mfma_f32_32x32x16_bf16 v[16:31], v[212:215], v[72:75], v[16:31]
    s_waitcnt lgkmcnt(0)
    v_mfma_f32_32x32x16_bf16 v[32:47], v[212:215], v[76:79], v[32:47]
L_f2_skip:
    s_waitcnt lgkmcnt(0)
    s_nop 7
    s_nop 1
    ds_write_b128 v6, v[24:27] offset:2048
    ds_write_b128 v6, v[28:31] offset:3072
    ds_write_b128 v6, v[32:35] offset:0
    ds_write_b128 v6, v[36:39] offset:1024
    ds_write_b128 v6, v[40:43] offset:4096
    ds_write_b128 v6, v[44:47] offset:5120
    s_waitcnt lgkmcnt(0)
    s_barrier
    ds_read_b128 v[64:67], v7
    ds_read_b128 v[68:71], v7 offset:1024
    ds_read_b128 v[72:75], v8
    ds_read_b128 v[76:79], v8 offset:1024
    ds_read_b128 v[80:83], v9
    ds_read_b128 v[84:87], v9 offset:1024
    s_waitcnt lgkmcnt(4)
    v_pk_add_f32 v[16:17], v[16:17], v[64:65]
    v_pk_add_f32 v[18:19], v[18:19], v[66:67]
    v_pk_add_f32 v[20:21], v[20:21], v[68:69]
    v_pk_add_f32 v[22:23], v[22:23], v[70:71]
    s_waitcnt lgkmcnt(2)
    v_pk_add_f32 v[16:17], v[16:17], v[72:73]
    v_pk_add_f32 v[18:19], v[18:19], v[74:75]
    v_pk_add_f32 v[20:21], v[20:21], v[76:77]
    v_pk_add_f32 v[22:23], v[22:23], v[78:79]
    s_waitcnt lgkmcnt(0)
    v_pk_add_f32 v[16:17], v[16:17], v[80:81]
    v_pk_add_f32 v[18:19], v[18:19], v[82:83]
    v_pk_add_f32 v[20:21], v[20:21], v[84:85]
    v_pk_add_f32 v[22:23], v[22:23], v[86:87]
    v_cvt_pk_bf16_f32 v24, v16, v17
    v_cvt_pk_bf16_f32 v25, v18, v19
    v_cvt_pk_bf16_f32 v26, v20, v21
    v_cvt_pk_bf16_f32 v27, v22, v23
    buffer_store_dwordx4 v[24:27], v10, s[20:23], s74 offen
L_k2_end:
    s_endpgm
L_x1_slow:
    buffer_wbl2 sc1
    s_waitcnt vmcnt(0)
    buffer_store_dword v4, v5, s[52:55], s24 offen offset:32 sc1
    s_branch L_x1_set
L_x1_inv:
    buffer_inv sc1
    s_waitcnt vmcnt(0)
    s_branch L_x1_go
L_x2_slow:
    buffer_wbl2 sc1
    s_waitcnt vmcnt(0)
    buffer_store_dword v4, v5, s[52:55], s24 offen offset:64 sc1
    s_branch L_x2_set
L_x2_inv:
    buffer_inv sc1
    s_waitcnt vmcnt(0)
    s_branch L_x2_go
L_f1_g:
    s_add_u32 m0, s10, 0
    s_add_u32 s13, s97, 81920
    buffer_load_dwordx4 v126, s[56:59], s13 offen lds
    s_add_u32 m0, s10, 8192
    s_add_u32 s13, s97, 802816
    buffer_load_dwordx4 v126, s[56:59], s13 offen lds
    s_add_u32 m0, s10, 16384
    s_add_u32 s13, s97, 98304
    buffer_load_dwordx4 v126, s[56:59], s13 offen lds
    s_add_u32 m0, s10, 24576
    s_add_u32 s13, s97, 819200
    buffer_load_dwordx4 v126, s[56:59], s13 offen lds
    s_add_u32 m0, s10, 65536
    s_add_u32 s13, s97, 114688
    buffer_load_dwordx4 v126, s[56:59], s13 offen lds
    s_add_u32 m0, s10, 73728
    s_add_u32 s13, s97, 835584
    buffer_load_dwordx4 v126, s[56:59], s13 offen lds
    s_add_u32 m0, s10, 81920
    s_add_u32 s13, s97, 131072
    buffer_load_dwordx4 v126, s[56:59], s13 offen lds
    s_add_u32 m0, s10, 90112
    s_add_u32 s13, s97, 851968
    buffer_load_dwordx4 v126, s[56:59], s13 offen lds
    s_add_u32 m0, s10, 147456
    s_add_u32 s13, s97, 147456
    buffer_load_dwordx4 v126, s[56:59], s13 offen lds
    s_add_u32 m0, s10, 155648
    s_add_u32 s13, s97, 163840
    buffer_load_dwordx4 v126, s[56:59], s13 offen lds
    s_waitcnt vmcnt(0)
    s_branch L_f1_gr
L_x3_slow:
    buffer_wbl2 sc1
    s_waitcnt vmcnt(0)
    buffer_store_dword v4, v5, s[52:55], s24 offen offset:96 sc1
    s_branch L_x3_set
L_x3_inv:
    buffer_inv sc1
    s_waitcnt vmcnt(0)
    s_branch L_x3_go
L_k2_slow:
    s_mov_b32 s15, 0x200000
    v_mov_b32 v44, 0xff61b1e6
    v_mov_b32 v45, 0xff61b1e6
L_k2_mx:
    buffer_load_dwordx4 v[12:15], v3, s[52:55], s15 offen sc1
    s_waitcnt vmcnt(0)
    v_mfma_f32_32x32x16_bf16 v[92:107], v[12:15], v[4:7], 0
    v_mfma_f32_32x32x16_bf16 v[108:123], v[12:15], v[8:11], 0
    s_nop 7
    s_nop 4
    v_max3_f32 v44, v92, v93, v44
    v_max3_f32 v44, v94, v95, v44
    v_max3_f32 v44, v96, v97, v44
    v_max3_f32 v44, v98, v99, v44
    v_max3_f32 v44, v100, v101, v44
    v_max3_f32 v44, v102, v103, v44
    v_max3_f32 v44, v104, v105, v44
    v_max3_f32 v44, v106, v107, v44
    v_max3_f32 v45, v108, v109, v45
    v_max3_f32 v45, v110, v111, v45
    v_max3_f32 v45, v112, v113, v45
    v_max3_f32 v45, v114, v115, v45
    v_max3_f32 v45, v116, v117, v45
    v_max3_f32 v45, v118, v119, v45
    v_max3_f32 v45, v120, v121, v45
    v_max3_f32 v45, v122, v123, v45
    s_add_u32 s15, s15, 2048
    s_cmp_lt_u32 s15, 0x220000
    s_cbranch_scc1 L_k2_mx
    v_mov_b32 v46, v44
    v_mov_b32 v47, v45
    s_nop 1
    v_permlane32_swap_b32 v44, v46
    v_permlane32_swap_b32 v45, v47
    s_nop 1
    v_max_f32 v44, v44, v46
    v_max_f32 v45, v45, v47
    s_waitcnt vmcnt(2)
    s_barrier
    ds_read_b128 v[12:15], v2
    s_mov_b64 exec, s[60:61]
    ds_read_b128 v[20:23], v2 offset:1024
    ds_read_b128 v[24:27], v2 offset:768
    s_mov_b64 exec, -1
    s_waitcnt lgkmcnt(0)
    v_mfma_f32_32x32x16_bf16 v[92:107], v[12:15], v[4:7], 0
    s_nop 7
    s_nop 3
    s_setprio 3
    v_sub_f32 v92, v92, v44
    v_sub_f32 v93, v93, v44
    v_sub_f32 v94, v94, v44
    v_sub_f32 v95, v95, v44
    v_sub_f32 v96, v96, v44
    v_sub_f32 v97, v97, v44
    v_sub_f32 v98, v98, v44
    v_sub_f32 v99, v99, v44
    v_sub_f32 v100, v100, v44
    v_sub_f32 v101, v101, v44
    v_sub_f32 v102, v102, v44
    v_sub_f32 v103, v103, v44
    v_sub_f32 v104, v104, v44
    v_sub_f32 v105, v105, v44
    v_sub_f32 v106, v106, v44
    v_sub_f32 v107, v107, v44
    v_exp_f32 v92, v92
    v_exp_f32 v93, v93
    s_mov_b64 exec, s[60:61]
    ds_read_b128 v[28:31], v2 offset:3072
    ds_read_b128 v[32:35], v2 offset:2816
    s_mov_b64 exec, -1
    s_add_u32 m0, s10, 16384
    s_add_u32 s13, s11, 16384
    buffer_load_dwordx4 v3, s[52:55], s13 offen sc1 lds
    s_add_u32 m0, s10, 81920
    s_add_u32 s13, s11, 81920
    buffer_load_dwordx4 v3, s[52:55], s13 offen sc1 lds
    v_exp_f32 v94, v94
    v_exp_f32 v95, v95
    v_exp_f32 v96, v96
    v_mfma_f32_32x32x16_bf16 v[108:123], v[12:15], v[8:11], 0
    ds_read_b128 v[16:19], v2 offset:2048
    v_exp_f32 v97, v97
    v_exp_f32 v98, v98
    v_exp_f32 v99, v99
    v_exp_f32 v100, v100
    v_exp_f32 v101, v101
    v_smfmac_f32_32x32x32_bf16 v[60:75], v[20:23], v[92:99], v43
    v_exp_f32 v102, v102
    v_exp_f32 v103, v103
    v_exp_f32 v104, v104
    v_exp_f32 v105, v105
    v_exp_f32 v106, v106
    v_exp_f32 v107, v107
    v_sub_f32 v108, v108, v45
    v_sub_f32 v109, v109, v45
    v_sub_f32 v110, v110, v45
    v_sub_f32 v111, v111, v45
    v_sub_f32 v112, v112, v45
    v_sub_f32 v113, v113, v45
    v_sub_f32 v114, v114, v45
    v_sub_f32 v115, v115, v45
    v_sub_f32 v116, v116, v45
    v_sub_f32 v117, v117, v45
    v_sub_f32 v118, v118, v45
    v_sub_f32 v119, v119, v45
    v_sub_f32 v120, v120, v45
    v_sub_f32 v121, v121, v45
    v_sub_f32 v122, v122, v45
    v_sub_f32 v123, v123, v45
    v_exp_f32 v108, v108
    v_exp_f32 v109, v109
    v_smfmac_f32_32x32x32_bf16 v[60:75], v[24:27], v[100:107], v43
    v_exp_f32 v110, v110
    v_exp_f32 v111, v111
    v_exp_f32 v112, v112
    s_waitcnt lgkmcnt(0)
    v_mfma_f32_32x32x16_bf16 v[92:107], v[16:19], v[4:7], 0
    s_add_u32 m0, s10, 49152
    s_add_u32 s13, s67, 0
    buffer_load_dwordx4 v125, s[44:47], s13 offen lds
    s_add_u32 m0, s10, 114688
    s_add_u32 s13, s67, 176128
    buffer_load_dwordx4 v125, s[44:47], s13 offen lds
    v_exp_f32 v113, v113
    v_exp_f32 v114, v114
    v_exp_f32 v115, v115
    v_exp_f32 v116, v116
    v_exp_f32 v117, v117
    v_smfmac_f32_32x32x32_bf16 v[76:91], v[20:23], v[108:115], v43
    v_exp_f32 v118, v118
    v_exp_f32 v119, v119
    v_exp_f32 v120, v120
    v_exp_f32 v121, v121
    v_exp_f32 v122, v122
    v_exp_f32 v123, v123
    s_setprio 2
    v_sub_f32 v92, v92, v44
    v_sub_f32 v93, v93, v44
    v_sub_f32 v94, v94, v44
    v_sub_f32 v95, v95, v44
    v_sub_f32 v96, v96, v44
    v_sub_f32 v97, v97, v44
    v_sub_f32 v98, v98, v44
    v_sub_f32 v99, v99, v44
    v_sub_f32 v100, v100, v44
    v_sub_f32 v101, v101, v44
    v_sub_f32 v102, v102, v44
    v_sub_f32 v103, v103, v44
    v_sub_f32 v104, v104, v44
    v_sub_f32 v105, v105, v44
    v_sub_f32 v106, v106, v44
    v_sub_f32 v107, v107, v44
    v_exp_f32 v92, v92
    v_exp_f32 v93, v93
    v_smfmac_f32_32x32x32_bf16 v[76:91], v[24:27], v[116:123], v43
    s_mov_b64 exec, s[60:61]
    ds_read_b128 v[20:23], v2 offset:5120
    ds_read_b128 v[24:27], v2 offset:4864
    s_mov_b64 exec, -1
    s_add_u32 m0, s10, 24576
    s_add_u32 s13, s11, 24576
    buffer_load_dwordx4 v3, s[52:55], s13 offen sc1 lds
    s_add_u32 m0, s10, 90112
    s_add_u32 s13, s11, 90112
    buffer_load_dwordx4 v3, s[52:55], s13 offen sc1 lds
    v_exp_f32 v94, v94
    v_exp_f32 v95, v95
    v_exp_f32 v96, v96
    v_mfma_f32_32x32x16_bf16 v[108:123], v[16:19], v[8:11], 0
    ds_read_b128 v[12:15], v2 offset:4096
    v_exp_f32 v97, v97
    v_exp_f32 v98, v98
    v_exp_f32 v99, v99
    v_exp_f32 v100, v100
    v_exp_f32 v101, v101
    v_smfmac_f32_32x32x32_bf16 v[60:75], v[28:31], v[92:99], v43
    v_exp_f32 v102, v102
    v_exp_f32 v103, v103
    v_exp_f32 v104, v104
    v_exp_f32 v105, v105
    v_exp_f32 v106, v106
    v_exp_f32 v107, v107
    v_sub_f32 v108, v108, v45
    v_sub_f32 v109, v109, v45
    v_sub_f32 v110, v110, v45
    v_sub_f32 v111, v111, v45
    v_sub_f32 v112, v112, v45
    v_sub_f32 v113, v113, v45
    v_sub_f32 v114, v114, v45
    v_sub_f32 v115, v115, v45
    v_sub_f32 v116, v116, v45
    v_sub_f32 v117, v117, v45
    v_sub_f32 v118, v118, v45
    v_sub_f32 v119, v119, v45
    v_sub_f32 v120, v120, v45
    v_sub_f32 v121, v121, v45
    v_sub_f32 v122, v122, v45
    v_sub_f32 v123, v123, v45
    v_exp_f32 v108, v108
    v_exp_f32 v109, v109
    v_smfmac_f32_32x32x32_bf16 v[60:75], v[32:35], v[100:107], v43
    v_exp_f32 v110, v110
    v_exp_f32 v111, v111
    v_exp_f32 v112, v112
    s_waitcnt lgkmcnt(0)
    v_mfma_f32_32x32x16_bf16 v[92:107], v[12:15], v[4:7], 0
    s_add_u32 m0, s10, 57344
    s_add_u32 s13, s67, 352256
    buffer_load_dwordx4 v125, s[44:47], s13 offen lds
    s_add_u32 m0, s10, 122880
    s_add_u32 s13, s67, 528384
    buffer_load_dwordx4 v125, s[44:47], s13 offen lds
    v_exp_f32 v113, v113
    v_exp_f32 v114, v114
    v_exp_f32 v115, v115
    v_exp_f32 v116, v116
    v_exp_f32 v117, v117
    v_smfmac_f32_32x32x32_bf16 v[76:91], v[28:31], v[108:115], v43
    v_exp_f32 v118, v118
    v_exp_f32 v119, v119
    v_exp_f32 v120, v120
    v_exp_f32 v121, v121
    v_exp_f32 v122, v122
    v_exp_f32 v123, v123
    s_setprio 1
    v_sub_f32 v92, v92, v44
    v_sub_f32 v93, v93, v44
    v_sub_f32 v94, v94, v44
    v_sub_f32 v95, v95, v44
    v_sub_f32 v96, v96, v44
    v_sub_f32 v97, v97, v44
    v_sub_f32 v98, v98, v44
    v_sub_f32 v99, v99, v44
    v_sub_f32 v100, v100, v44
    v_sub_f32 v101, v101, v44
    v_sub_f32 v102, v102, v44
    v_sub_f32 v103, v103, v44
    v_sub_f32 v104, v104, v44
    v_sub_f32 v105, v105, v44
    v_sub_f32 v106, v106, v44
    v_sub_f32 v107, v107, v44
    v_exp_f32 v92, v92
    v_exp_f32 v93, v93
    v_smfmac_f32_32x32x32_bf16 v[76:91], v[32:35], v[116:123], v43
    s_mov_b64 exec, s[60:61]
    ds_read_b128 v[28:31], v2 offset:7168
    ds_read_b128 v[32:35], v2 offset:6912
    s_mov_b64 exec, -1
    v_exp_f32 v94, v94
    v_exp_f32 v95, v95
    v_exp_f32 v96, v96
    v_mfma_f32_32x32x16_bf16 v[108:123], v[12:15], v[8:11], 0
    ds_read_b128 v[16:19], v2 offset:6144
    v_exp_f32 v97, v97
    v_exp_f32 v98, v98
    v_exp_f32 v99, v99
    v_exp_f32 v100, v100
    v_exp_f32 v101, v101
    v_smfmac_f32_32x32x32_bf16 v[60:75], v[20:23], v[92:99], v43
    v_exp_f32 v102, v102
    v_exp_f32 v103, v103
    v_exp_f32 v104, v104
    v_exp_f32 v105, v105
    v_exp_f32 v106, v106
    v_exp_f32 v107, v107
    s_setprio 0
    v_sub_f32 v108, v108, v45
    v_sub_f32 v109, v109, v45
    v_sub_f32 v110, v110, v45
    v_sub_f32 v111, v111, v45
    v_sub_f32 v112, v112, v45
    v_sub_f32 v113, v113, v45
    v_sub_f32 v114, v114, v45
    v_sub_f32 v115, v115, v45
    v_sub_f32 v116, v116, v45
    v_sub_f32 v117, v117, v45
    v_sub_f32 v118, v118, v45
    v_sub_f32 v119, v119, v45
    v_sub_f32 v120, v120, v45
    v_sub_f32 v121, v121, v45
    v_sub_f32 v122, v122, v45
    v_sub_f32 v123, v123, v45
    v_exp_f32 v108, v108
    v_exp_f32 v109, v109
    v_smfmac_f32_32x32x32_bf16 v[60:75], v[24:27], v[100:107], v43
    v_exp_f32 v110, v110
    v_exp_f32 v111, v111
    v_exp_f32 v112, v112
    s_waitcnt lgkmcnt(0)
    v_mfma_f32_32x32x16_bf16 v[92:107], v[16:19], v[4:7], 0
    s_add_u32 m0, s66, 0
    s_add_u32 s13, s67, 704512
    buffer_load_dwordx4 v125, s[44:47], s13 offen lds
    s_add_u32 m0, s66, 1024
    s_add_u32 s13, s67, 880640
    buffer_load_dwordx4 v125, s[44:47], s13 offen lds
    v_exp_f32 v113, v113
    v_exp_f32 v114, v114
    v_exp_f32 v115, v115
    v_exp_f32 v116, v116
    v_exp_f32 v117, v117
    v_smfmac_f32_32x32x32_bf16 v[76:91], v[20:23], v[108:115], v43
    v_exp_f32 v118, v118
    v_exp_f32 v119, v119
    v_exp_f32 v120, v120
    v_exp_f32 v121, v121
    v_exp_f32 v122, v122
    v_exp_f32 v123, v123
    s_waitcnt vmcnt(4)
    s_barrier
    s_setprio 3
    v_sub_f32 v92, v92, v44
    v_sub_f32 v93, v93, v44
    v_sub_f32 v94, v94, v44
    v_sub_f32 v95, v95, v44
    v_sub_f32 v96, v96, v44
    v_sub_f32 v97, v97, v44
    v_sub_f32 v98, v98, v44
    v_sub_f32 v99, v99, v44
    v_sub_f32 v100, v100, v44
    v_sub_f32 v101, v101, v44
    v_sub_f32 v102, v102, v44
    v_sub_f32 v103, v103, v44
    v_sub_f32 v104, v104, v44
    v_sub_f32 v105, v105, v44
    v_sub_f32 v106, v106, v44
    v_sub_f32 v107, v107, v44
    v_exp_f32 v92, v92
    v_exp_f32 v93, v93
    v_smfmac_f32_32x32x32_bf16 v[76:91], v[24:27], v[116:123], v43
    s_mov_b64 exec, s[60:61]
    ds_read_b128 v[20:23], v2 offset:9216
    ds_read_b128 v[24:27], v2 offset:8960
    s_mov_b64 exec, -1
    v_exp_f32 v94, v94
    v_exp_f32 v95, v95
    v_exp_f32 v96, v96
    v_mfma_f32_32x32x16_bf16 v[108:123], v[16:19], v[8:11], 0
    ds_read_b128 v[12:15], v2 offset:8192
    v_exp_f32 v97, v97
    v_exp_f32 v98, v98
    v_exp_f32 v99, v99
    v_exp_f32 v100, v100
    v_exp_f32 v101, v101
    v_smfmac_f32_32x32x32_bf16 v[60:75], v[28:31], v[92:99], v43
    v_exp_f32 v102, v102
    v_exp_f32 v103, v103
    v_exp_f32 v104, v104
    v_exp_f32 v105, v105
    v_exp_f32 v106, v106
    v_exp_f32 v107, v107
    v_sub_f32 v108, v108, v45
    v_sub_f32 v109, v109, v45
    v_sub_f32 v110, v110, v45
    v_sub_f32 v111, v111, v45
    v_sub_f32 v112, v112, v45
    v_sub_f32 v113, v113, v45
    v_sub_f32 v114, v114, v45
    v_sub_f32 v115, v115, v45
    v_sub_f32 v116, v116, v45
    v_sub_f32 v117, v117, v45
    v_sub_f32 v118, v118, v45
    v_sub_f32 v119, v119, v45
    v_sub_f32 v120, v120, v45
    v_sub_f32 v121, v121, v45
    v_sub_f32 v122, v122, v45
    v_sub_f32 v123, v123, v45
    v_exp_f32 v108, v108
    v_exp_f32 v109, v109
    v_smfmac_f32_32x32x32_bf16 v[60:75], v[32:35], v[100:107], v43
    v_exp_f32 v110, v110
    v_exp_f32 v111, v111
    v_exp_f32 v112, v112
    s_waitcnt lgkmcnt(0)
    v_mfma_f32_32x32x16_bf16 v[92:107], v[12:15], v[4:7], 0
    s_add_u32 m0, s66, 2048
    s_add_u32 s13, s67, 1056768
    buffer_load_dwordx4 v125, s[44:47], s13 offen lds
    s_add_u32 m0, s66, 3072
    s_add_u32 s13, s67, 1232896
    buffer_load_dwordx4 v125, s[44:47], s13 offen lds
    v_exp_f32 v113, v113
    v_exp_f32 v114, v114
    v_exp_f32 v115, v115
    v_exp_f32 v116, v116
    v_exp_f32 v117, v117
    v_smfmac_f32_32x32x32_bf16 v[76:91], v[28:31], v[108:115], v43
    v_exp_f32 v118, v118
    v_exp_f32 v119, v119
    v_exp_f32 v120, v120
    v_exp_f32 v121, v121
    v_exp_f32 v122, v122
    v_exp_f32 v123, v123
    v_sub_f32 v92, v92, v44
    v_sub_f32 v93, v93, v44
    v_sub_f32 v94, v94, v44
    v_sub_f32 v95, v95, v44
    v_sub_f32 v96, v96, v44
    v_sub_f32 v97, v97, v44
    v_sub_f32 v98, v98, v44
    v_sub_f32 v99, v99, v44
    v_sub_f32 v100, v100, v44
    v_sub_f32 v101, v101, v44
    v_sub_f32 v102, v102, v44
    v_sub_f32 v103, v103, v44
    v_sub_f32 v104, v104, v44
    v_sub_f32 v105, v105, v44
    v_sub_f32 v106, v106, v44
    v_sub_f32 v107, v107, v44
    v_exp_f32 v92, v92
    v_exp_f32 v93, v93
    v_smfmac_f32_32x32x32_bf16 v[76:91], v[32:35], v[116:123], v43
    s_mov_b64 exec, s[60:61]
    ds_read_b128 v[28:31], v2 offset:11264
    ds_read_b128 v[32:35], v2 offset:11008
    s_mov_b64 exec, -1
    s_add_u32 m0, s10, 32768
    s_add_u32 s13, s11, 32768
    buffer_load_dwordx4 v3, s[52:55], s13 offen sc1 lds
    buffer_load_dword v127, v3, s[52:55], s100 offen offset:0 sc1
    v_exp_f32 v94, v94
    v_exp_f32 v95, v95
    v_exp_f32 v96, v96
    v_mfma_f32_32x32x16_bf16 v[108:123], v[12:15], v[8:11], 0
    ds_read_b128 v[16:19], v2 offset:10240
    v_exp_f32 v97, v97
    v_exp_f32 v98, v98
    v_exp_f32 v99, v99
    v_exp_f32 v100, v100
    v_exp_f32 v101, v101
    v_smfmac_f32_32x32x32_bf16 v[60:75], v[20:23], v[92:99], v43
    v_exp_f32 v102, v102
    v_exp_f32 v103, v103
    v_exp_f32 v104, v104
    v_exp_f32 v105, v105
    v_exp_f32 v106, v106
    v_exp_f32 v107, v107
    v_sub_f32 v108, v108, v45
    v_sub_f32 v109, v109, v45
    v_sub_f32 v110, v110, v45
    v_sub_f32 v111, v111, v45
    v_sub_f32 v112, v112, v45
    v_sub_f32 v113, v113, v45
    v_sub_f32 v114, v114, v45
    v_sub_f32 v115, v115, v45
    v_sub_f32 v116, v116, v45
    v_sub_f32 v117, v117, v45
    v_sub_f32 v118, v118, v45
    v_sub_f32 v119, v119, v45
    v_sub_f32 v120, v120, v45
    v_sub_f32 v121, v121, v45
    v_sub_f32 v122, v122, v45
    v_sub_f32 v123, v123, v45
    v_exp_f32 v108, v108
    v_exp_f32 v109, v109
    v_smfmac_f32_32x32x32_bf16 v[60:75], v[24:27], v[100:107], v43
    v_exp_f32 v110, v110
    v_exp_f32 v111, v111
    v_exp_f32 v112, v112
    s_waitcnt lgkmcnt(0)
    v_mfma_f32_32x32x16_bf16 v[92:107], v[16:19], v[4:7], 0
    v_exp_f32 v113, v113
    v_exp_f32 v114, v114
    v_exp_f32 v115, v115
    v_exp_f32 v116, v116
    v_exp_f32 v117, v117
    v_smfmac_f32_32x32x32_bf16 v[76:91], v[20:23], v[108:115], v43
    v_exp_f32 v118, v118
    v_exp_f32 v119, v119
    v_exp_f32 v120, v120
    v_exp_f32 v121, v121
    v_exp_f32 v122, v122
    v_exp_f32 v123, v123
    v_sub_f32 v92, v92, v44
    v_sub_f32 v93, v93, v44
    v_sub_f32 v94, v94, v44
    v_sub_f32 v95, v95, v44
    v_sub_f32 v96, v96, v44
    v_sub_f32 v97, v97, v44
    v_sub_f32 v98, v98, v44
    v_sub_f32 v99, v99, v44
    v_sub_f32 v100, v100, v44
    v_sub_f32 v101, v101, v44
    v_sub_f32 v102, v102, v44
    v_sub_f32 v103, v103, v44
    v_sub_f32 v104, v104, v44
    v_sub_f32 v105, v105, v44
    v_sub_f32 v106, v106, v44
    v_sub_f32 v107, v107, v44
    v_exp_f32 v92, v92
    v_exp_f32 v93, v93
    v_smfmac_f32_32x32x32_bf16 v[76:91], v[24:27], v[116:123], v43
    s_mov_b64 exec, s[60:61]
    ds_read_b128 v[20:23], v2 offset:13312
    ds_read_b128 v[24:27], v2 offset:13056
    s_mov_b64 exec, -1
    s_add_u32 m0, s10, 98304
    s_add_u32 s13, s11, 98304
    buffer_load_dwordx4 v3, s[52:55], s13 offen sc1 lds
    v_exp_f32 v94, v94
    v_exp_f32 v95, v95
    v_exp_f32 v96, v96
    v_mfma_f32_32x32x16_bf16 v[108:123], v[16:19], v[8:11], 0
    ds_read_b128 v[12:15], v2 offset:12288
    s_waitcnt vmcnt(11)
    ds_read_b64_tr_b16 v[128:129], v41 offset:49152
    ds_read_b64_tr_b16 v[130:131], v41 offset:49408
    ds_read_b64_tr_b16 v[132:133], v42 offset:49152
    ds_read_b64_tr_b16 v[134:135], v42 offset:49408
    v_exp_f32 v97, v97
    v_exp_f32 v98, v98
    v_exp_f32 v99, v99
    v_exp_f32 v100, v100
    v_exp_f32 v101, v101
    v_smfmac_f32_32x32x32_bf16 v[60:75], v[28:31], v[92:99], v43
    v_exp_f32 v102, v102
    v_exp_f32 v103, v103
    v_exp_f32 v104, v104
    v_exp_f32 v105, v105
    v_exp_f32 v106, v106
    v_exp_f32 v107, v107
    v_sub_f32 v108, v108, v45
    v_sub_f32 v109, v109, v45
    v_sub_f32 v110, v110, v45
    v_sub_f32 v111, v111, v45
    v_sub_f32 v112, v112, v45
    v_sub_f32 v113, v113, v45
    v_sub_f32 v114, v114, v45
    v_sub_f32 v115, v115, v45
    v_sub_f32 v116, v116, v45
    v_sub_f32 v117, v117, v45
    v_sub_f32 v118, v118, v45
    v_sub_f32 v119, v119, v45
    v_sub_f32 v120, v120, v45
    v_sub_f32 v121, v121, v45
    v_sub_f32 v122, v122, v45
    v_sub_f32 v123, v123, v45
    v_exp_f32 v108, v108
    v_exp_f32 v109, v109
    v_smfmac_f32_32x32x32_bf16 v[60:75], v[32:35], v[100:107], v43
    v_exp_f32 v110, v110
    v_exp_f32 v111, v111
    v_exp_f32 v112, v112
    s_waitcnt lgkmcnt(0)
    v_mfma_f32_32x32x16_bf16 v[92:107], v[12:15], v[4:7], 0
    s_add_u32 m0, s10, 49152
    s_add_u32 s13, s67, 44032
    buffer_load_dwordx4 v125, s[44:47], s13 offen lds
    s_add_u32 m0, s10, 114688
    s_add_u32 s13, s67, 220160
    buffer_load_dwordx4 v125, s[44:47], s13 offen lds
    v_exp_f32 v113, v113
    v_exp_f32 v114, v114
    v_exp_f32 v115, v115
    v_exp_f32 v116, v116
    v_exp_f32 v117, v117
    v_smfmac_f32_32x32x32_bf16 v[76:91], v[28:31], v[108:115], v43
    v_exp_f32 v118, v118
    v_exp_f32 v119, v119
    v_exp_f32 v120, v120
    v_exp_f32 v121, v121
    v_exp_f32 v122, v122
    v_exp_f32 v123, v123
    v_sub_f32 v92, v92, v44
    v_sub_f32 v93, v93, v44
    v_sub_f32 v94, v94, v44
    v_sub_f32 v95, v95, v44
    v_sub_f32 v96, v96, v44
    v_sub_f32 v97, v97, v44
    v_sub_f32 v98, v98, v44
    v_sub_f32 v99, v99, v44
    v_sub_f32 v100, v100, v44
    v_sub_f32 v101, v101, v44
    v_sub_f32 v102, v102, v44
    v_sub_f32 v103, v103, v44
    v_sub_f32 v104, v104, v44
    v_sub_f32 v105, v105, v44
    v_sub_f32 v106, v106, v44
    v_sub_f32 v107, v107, v44
    v_exp_f32 v92, v92
    v_exp_f32 v93, v93
    v_smfmac_f32_32x32x32_bf16 v[76:91], v[32:35], v[116:123], v43
    s_mov_b64 exec, s[60:61]
    ds_read_b128 v[28:31], v2 offset:15360
    ds_read_b128 v[32:35], v2 offset:15104
    s_mov_b64 exec, -1
    s_add_u32 m0, s10, 40960
    s_add_u32 s13, s11, 40960
    buffer_load_dwordx4 v3, s[52:55], s13 offen sc1 lds
    v_exp_f32 v94, v94
    v_exp_f32 v95, v95
    v_exp_f32 v96, v96
    v_mfma_f32_32x32x16_bf16 v[108:123], v[12:15], v[8:11], 0
    ds_read_b128 v[16:19], v2 offset:14336
    s_waitcnt vmcnt(10)
    ds_read_b64_tr_b16 v[136:137], v41 offset:57344
    ds_read_b64_tr_b16 v[138:139], v41 offset:57600
    ds_read_b64_tr_b16 v[140:141], v42 offset:57344
    ds_read_b64_tr_b16 v[142:143], v42 offset:57600
    v_exp_f32 v97, v97
    v_exp_f32 v98, v98
    v_exp_f32 v99, v99
    v_exp_f32 v100, v100
    v_exp_f32 v101, v101
    v_smfmac_f32_32x32x32_bf16 v[60:75], v[20:23], v[92:99], v43
    v_exp_f32 v102, v102
    v_exp_f32 v103, v103
    v_exp_f32 v104, v104
    v_exp_f32 v105, v105
    v_exp_f32 v106, v106
    v_exp_f32 v107, v107
    v_sub_f32 v108, v108, v45
    v_sub_f32 v109, v109, v45
    v_sub_f32 v110, v110, v45
    v_sub_f32 v111, v111, v45
    v_sub_f32 v112, v112, v45
    v_sub_f32 v113, v113, v45
    v_sub_f32 v114, v114, v45
    v_sub_f32 v115, v115, v45
    v_sub_f32 v116, v116, v45
    v_sub_f32 v117, v117, v45
    v_sub_f32 v118, v118, v45
    v_sub_f32 v119, v119, v45
    v_sub_f32 v120, v120, v45
    v_sub_f32 v121, v121, v45
    v_sub_f32 v122, v122, v45
    v_sub_f32 v123, v123, v45
    v_exp_f32 v108, v108
    v_exp_f32 v109, v109
    v_smfmac_f32_32x32x32_bf16 v[60:75], v[24:27], v[100:107], v43
    v_exp_f32 v110, v110
    v_exp_f32 v111, v111
    v_exp_f32 v112, v112
    s_waitcnt lgkmcnt(0)
    v_mfma_f32_32x32x16_bf16 v[92:107], v[16:19], v[4:7], 0
    s_add_u32 m0, s10, 57344
    s_add_u32 s13, s67, 396288
    buffer_load_dwordx4 v125, s[44:47], s13 offen lds
    s_add_u32 m0, s10, 122880
    s_add_u32 s13, s67, 572416
    buffer_load_dwordx4 v125, s[44:47], s13 offen lds
    v_exp_f32 v113, v113
    v_exp_f32 v114, v114
    v_exp_f32 v115, v115
    v_exp_f32 v116, v116
    v_exp_f32 v117, v117
    v_smfmac_f32_32x32x32_bf16 v[76:91], v[20:23], v[108:115], v43
    v_exp_f32 v118, v118
    v_exp_f32 v119, v119
    v_exp_f32 v120, v120
    v_exp_f32 v121, v121
    v_exp_f32 v122, v122
    v_exp_f32 v123, v123
    v_sub_f32 v92, v92, v44
    v_sub_f32 v93, v93, v44
    v_sub_f32 v94, v94, v44
    v_sub_f32 v95, v95, v44
    v_sub_f32 v96, v96, v44
    v_sub_f32 v97, v97, v44
    v_sub_f32 v98, v98, v44
    v_sub_f32 v99, v99, v44
    v_sub_f32 v100, v100, v44
    v_sub_f32 v101, v101, v44
    v_sub_f32 v102, v102, v44
    v_sub_f32 v103, v103, v44
    v_sub_f32 v104, v104, v44
    v_sub_f32 v105, v105, v44
    v_sub_f32 v106, v106, v44
    v_sub_f32 v107, v107, v44
    v_exp_f32 v92, v92
    v_exp_f32 v93, v93
    v_smfmac_f32_32x32x32_bf16 v[76:91], v[24:27], v[116:123], v43
    s_mov_b64 exec, s[60:61]
    ds_read_b128 v[20:23], v2 offset:17408
    ds_read_b128 v[24:27], v2 offset:17152
    s_mov_b64 exec, -1
    s_add_u32 m0, s10, 106496
    s_add_u32 s13, s11, 106496
    buffer_load_dwordx4 v3, s[52:55], s13 offen sc1 lds
    v_exp_f32 v94, v94
    v_exp_f32 v95, v95
    v_exp_f32 v96, v96
    v_mfma_f32_32x32x16_bf16 v[108:123], v[16:19], v[8:11], 0
    ds_read_b128 v[12:15], v2 offset:16384
    s_waitcnt vmcnt(11)
    ds_read_b64_tr_b16 v[144:145], v124 offset:0
    ds_read_b64_tr_b16 v[146:147], v124 offset:256
    ds_read_b64_tr_b16 v[148:149], v124 offset:1024
    ds_read_b64_tr_b16 v[150:151], v124 offset:1280
    v_exp_f32 v97, v97
    v_exp_f32 v98, v98
    v_exp_f32 v99, v99
    v_exp_f32 v100, v100
    v_exp_f32 v101, v101
    v_smfmac_f32_32x32x32_bf16 v[60:75], v[28:31], v[92:99], v43
    v_exp_f32 v102, v102
    v_exp_f32 v103, v103
    v_exp_f32 v104, v104
    v_exp_f32 v105, v105
    v_exp_f32 v106, v106
    v_exp_f32 v107, v107
    v_sub_f32 v108, v108, v45
    v_sub_f32 v109, v109, v45
    v_sub_f32 v110, v110, v45
    v_sub_f32 v111, v111, v45
    v_sub_f32 v112, v112, v45
    v_sub_f32 v113, v113, v45
    v_sub_f32 v114, v114, v45
    v_sub_f32 v115, v115, v45
    v_sub_f32 v116, v116, v45
    v_sub_f32 v117, v117, v45
    v_sub_f32 v118, v118, v45
    v_sub_f32 v119, v119, v45
    v_sub_f32 v120, v120, v45
    v_sub_f32 v121, v121, v45
    v_sub_f32 v122, v122, v45
    v_sub_f32 v123, v123, v45
    v_exp_f32 v108, v108
    v_exp_f32 v109, v109
    v_smfmac_f32_32x32x32_bf16 v[60:75], v[32:35], v[100:107], v43
    v_exp_f32 v110, v110
    v_exp_f32 v111, v111
    v_exp_f32 v112, v112
    s_waitcnt lgkmcnt(0)
    v_mfma_f32_32x32x16_bf16 v[92:107], v[12:15], v[4:7], 0
    s_add_u32 m0, s66, 0
    s_add_u32 s13, s67, 748544
    buffer_load_dwordx4 v125, s[44:47], s13 offen lds
    s_add_u32 m0, s66, 1024
    s_add_u32 s13, s67, 924672
    buffer_load_dwordx4 v125, s[44:47], s13 offen lds
    v_exp_f32 v113, v113
    v_exp_f32 v114, v114
    v_exp_f32 v115, v115
    v_exp_f32 v116, v116
    v_exp_f32 v117, v117
    v_smfmac_f32_32x32x32_bf16 v[76:91], v[28:31], v[108:115], v43
    v_exp_f32 v118, v118
    v_exp_f32 v119, v119
    v_exp_f32 v120, v120
    v_exp_f32 v121, v121
    v_exp_f32 v122, v122
    v_exp_f32 v123, v123
    v_sub_f32 v92, v92, v44
    v_sub_f32 v93, v93, v44
    v_sub_f32 v94, v94, v44
    v_sub_f32 v95, v95, v44
    v_sub_f32 v96, v96, v44
    v_sub_f32 v97, v97, v44
    v_sub_f32 v98, v98, v44
    v_sub_f32 v99, v99, v44
    v_sub_f32 v100, v100, v44
    v_sub_f32 v101, v101, v44
    v_sub_f32 v102, v102, v44
    v_sub_f32 v103, v103, v44
    v_sub_f32 v104, v104, v44
    v_sub_f32 v105, v105, v44
    v_sub_f32 v106, v106, v44
    v_sub_f32 v107, v107, v44
    v_exp_f32 v92, v92
    v_exp_f32 v93, v93
    v_smfmac_f32_32x32x32_bf16 v[76:91], v[32:35], v[116:123], v43
    s_mov_b64 exec, s[60:61]
    ds_read_b128 v[28:31], v2 offset:19456
    ds_read_b128 v[32:35], v2 offset:19200
    s_mov_b64 exec, -1
    v_exp_f32 v94, v94
    v_exp_f32 v95, v95
    v_exp_f32 v96, v96
    v_mfma_f32_32x32x16_bf16 v[108:123], v[12:15], v[8:11], 0
    ds_read_b128 v[16:19], v2 offset:18432
    s_waitcnt vmcnt(11)
    ds_read_b64_tr_b16 v[152:153], v124 offset:2048
    ds_read_b64_tr_b16 v[154:155], v124 offset:2304
    ds_read_b64_tr_b16 v[156:157], v124 offset:3072
    ds_read_b64_tr_b16 v[158:159], v124 offset:3328
    v_exp_f32 v97, v97
    v_exp_f32 v98, v98
    v_exp_f32 v99, v99
    v_exp_f32 v100, v100
    v_exp_f32 v101, v101
    v_smfmac_f32_32x32x32_bf16 v[60:75], v[20:23], v[92:99], v43
    v_exp_f32 v102, v102
    v_exp_f32 v103, v103
    v_exp_f32 v104, v104
    v_exp_f32 v105, v105
    v_exp_f32 v106, v106
    v_exp_f32 v107, v107
    v_sub_f32 v108, v108, v45
    v_sub_f32 v109, v109, v45
    v_sub_f32 v110, v110, v45
    v_sub_f32 v111, v111, v45
    v_sub_f32 v112, v112, v45
    v_sub_f32 v113, v113, v45
    v_sub_f32 v114, v114, v45
    v_sub_f32 v115, v115, v45
    v_sub_f32 v116, v116, v45
    v_sub_f32 v117, v117, v45
    v_sub_f32 v118, v118, v45
    v_sub_f32 v119, v119, v45
    v_sub_f32 v120, v120, v45
    v_sub_f32 v121, v121, v45
    v_sub_f32 v122, v122, v45
    v_sub_f32 v123, v123, v45
    v_exp_f32 v108, v108
    v_exp_f32 v109, v109
    v_smfmac_f32_32x32x32_bf16 v[60:75], v[24:27], v[100:107], v43
    v_exp_f32 v110, v110
    v_exp_f32 v111, v111
    v_exp_f32 v112, v112
    s_waitcnt lgkmcnt(0)
    v_mfma_f32_32x32x16_bf16 v[92:107], v[16:19], v[4:7], 0
    s_add_u32 m0, s66, 2048
    s_add_u32 s13, s67, 1100800
    buffer_load_dwordx4 v125, s[44:47], s13 offen lds
    s_add_u32 m0, s66, 3072
    s_add_u32 s13, s67, 1276928
    buffer_load_dwordx4 v125, s[44:47], s13 offen lds
    v_exp_f32 v113, v113
    v_exp_f32 v114, v114
    v_exp_f32 v115, v115
    v_exp_f32 v116, v116
    v_exp_f32 v117, v117
    v_smfmac_f32_32x32x32_bf16 v[76:91], v[20:23], v[108:115], v43
    v_exp_f32 v118, v118
    v_exp_f32 v119, v119
    v_exp_f32 v120, v120
    v_exp_f32 v121, v121
    v_exp_f32 v122, v122
    v_exp_f32 v123, v123
    s_setprio 2
    v_sub_f32 v92, v92, v44
    v_sub_f32 v93, v93, v44
    v_sub_f32 v94, v94, v44
    v_sub_f32 v95, v95, v44
    v_sub_f32 v96, v96, v44
    v_sub_f32 v97, v97, v44
    v_sub_f32 v98, v98, v44
    v_sub_f32 v99, v99, v44
    v_sub_f32 v100, v100, v44
    v_sub_f32 v101, v101, v44
    v_sub_f32 v102, v102, v44
    v_sub_f32 v103, v103, v44
    v_sub_f32 v104, v104, v44
    v_sub_f32 v105, v105, v44
    v_sub_f32 v106, v106, v44
    v_sub_f32 v107, v107, v44
    v_exp_f32 v92, v92
    v_exp_f32 v93, v93
    v_smfmac_f32_32x32x32_bf16 v[76:91], v[24:27], v[116:123], v43
    s_mov_b64 exec, s[60:61]
    ds_read_b128 v[20:23], v2 offset:21504
    ds_read_b128 v[24:27], v2 offset:21248
    s_mov_b64 exec, -1
    buffer_load_dword v127, v3, s[52:55], s63 offen offset:0 sc1
    buffer_load_dword v127, v3, s[52:55], s101 offen offset:0 sc1
    v_exp_f32 v94, v94
    v_exp_f32 v95, v95
    v_exp_f32 v96, v96
    v_mfma_f32_32x32x16_bf16 v[108:123], v[16:19], v[8:11], 0
    ds_read_b128 v[12:15], v2 offset:20480
    v_exp_f32 v97, v97
    v_exp_f32 v98, v98
    v_exp_f32 v99, v99
    v_exp_f32 v100, v100
    v_exp_f32 v101, v101
    v_smfmac_f32_32x32x32_bf16 v[60:75], v[28:31], v[92:99], v43
    v_exp_f32 v102, v102
    v_exp_f32 v103, v103
    v_exp_f32 v104, v104
    v_exp_f32 v105, v105
    v_exp_f32 v106, v106
    v_exp_f32 v107, v107
    v_sub_f32 v108, v108, v45
    v_sub_f32 v109, v109, v45
    v_sub_f32 v110, v110, v45
    v_sub_f32 v111, v111, v45
    v_sub_f32 v112, v112, v45
    v_sub_f32 v113, v113, v45
    v_sub_f32 v114, v114, v45
    v_sub_f32 v115, v115, v45
    v_sub_f32 v116, v116, v45
    v_sub_f32 v117, v117, v45
    v_sub_f32 v118, v118, v45
    v_sub_f32 v119, v119, v45
    v_sub_f32 v120, v120, v45
    v_sub_f32 v121, v121, v45
    v_sub_f32 v122, v122, v45
    v_sub_f32 v123, v123, v45
    v_exp_f32 v108, v108
    v_exp_f32 v109, v109
    v_smfmac_f32_32x32x32_bf16 v[60:75], v[32:35], v[100:107], v43
    v_exp_f32 v110, v110
    v_exp_f32 v111, v111
    v_exp_f32 v112, v112
    s_waitcnt lgkmcnt(0)
    v_mfma_f32_32x32x16_bf16 v[92:107], v[12:15], v[4:7], 0
    v_exp_f32 v113, v113
    v_exp_f32 v114, v114
    v_exp_f32 v115, v115
    v_exp_f32 v116, v116
    v_exp_f32 v117, v117
    v_smfmac_f32_32x32x32_bf16 v[76:91], v[28:31], v[108:115], v43
    v_exp_f32 v118, v118
    v_exp_f32 v119, v119
    v_exp_f32 v120, v120
    v_exp_f32 v121, v121
    v_exp_f32 v122, v122
    v_exp_f32 v123, v123
    v_sub_f32 v92, v92, v44
    v_sub_f32 v93, v93, v44
    v_sub_f32 v94, v94, v44
    v_sub_f32 v95, v95, v44
    v_sub_f32 v96, v96, v44
    v_sub_f32 v97, v97, v44
    v_sub_f32 v98, v98, v44
    v_sub_f32 v99, v99, v44
    v_sub_f32 v100, v100, v44
    v_sub_f32 v101, v101, v44
    v_sub_f32 v102, v102, v44
    v_sub_f32 v103, v103, v44
    v_sub_f32 v104, v104, v44
    v_sub_f32 v105, v105, v44
    v_sub_f32 v106, v106, v44
    v_sub_f32 v107, v107, v44
    v_exp_f32 v92, v92
    v_exp_f32 v93, v93
    v_smfmac_f32_32x32x32_bf16 v[76:91], v[32:35], v[116:123], v43
    s_mov_b64 exec, s[60:61]
    ds_read_b128 v[28:31], v2 offset:23552
    ds_read_b128 v[32:35], v2 offset:23296
    s_mov_b64 exec, -1
    v_exp_f32 v94, v94
    v_exp_f32 v95, v95
    v_exp_f32 v96, v96
    v_mfma_f32_32x32x16_bf16 v[108:123], v[12:15], v[8:11], 0
    ds_read_b128 v[16:19], v2 offset:22528
    s_waitcnt vmcnt(10)
    ds_read_b64_tr_b16 v[160:161], v41 offset:49152
    ds_read_b64_tr_b16 v[162:163], v41 offset:49408
    ds_read_b64_tr_b16 v[164:165], v42 offset:49152
    ds_read_b64_tr_b16 v[166:167], v42 offset:49408
    v_exp_f32 v97, v97
    v_exp_f32 v98, v98
    v_exp_f32 v99, v99
    v_exp_f32 v100, v100
    v_exp_f32 v101, v101
    v_smfmac_f32_32x32x32_bf16 v[60:75], v[20:23], v[92:99], v43
    v_exp_f32 v102, v102
    v_exp_f32 v103, v103
    v_exp_f32 v104, v104
    v_exp_f32 v105, v105
    v_exp_f32 v106, v106
    v_exp_f32 v107, v107
    v_sub_f32 v108, v108, v45
    v_sub_f32 v109, v109, v45
    v_sub_f32 v110, v110, v45
    v_sub_f32 v111, v111, v45
    v_sub_f32 v112, v112, v45
    v_sub_f32 v113, v113, v45
    v_sub_f32 v114, v114, v45
    v_sub_f32 v115, v115, v45
    v_sub_f32 v116, v116, v45
    v_sub_f32 v117, v117, v45
    v_sub_f32 v118, v118, v45
    v_sub_f32 v119, v119, v45
    v_sub_f32 v120, v120, v45
    v_sub_f32 v121, v121, v45
    v_sub_f32 v122, v122, v45
    v_sub_f32 v123, v123, v45
    v_exp_f32 v108, v108
    v_exp_f32 v109, v109
    v_smfmac_f32_32x32x32_bf16 v[60:75], v[24:27], v[100:107], v43
    v_exp_f32 v110, v110
    v_exp_f32 v111, v111
    v_exp_f32 v112, v112
    s_waitcnt lgkmcnt(0)
    v_mfma_f32_32x32x16_bf16 v[92:107], v[16:19], v[4:7], 0
    s_add_u32 m0, s10, 49152
    s_add_u32 s13, s11, 49152
    buffer_load_dwordx4 v3, s[52:55], s13 offen sc1 lds
    s_add_u32 m0, s10, 114688
    s_add_u32 s13, s11, 114688
    buffer_load_dwordx4 v3, s[52:55], s13 offen sc1 lds
    v_exp_f32 v113, v113
    v_exp_f32 v114, v114
    v_exp_f32 v115, v115
    v_exp_f32 v116, v116
    v_exp_f32 v117, v117
    v_smfmac_f32_32x32x32_bf16 v[76:91], v[20:23], v[108:115], v43
    v_exp_f32 v118, v118
    v_exp_f32 v119, v119
    v_exp_f32 v120, v120
    v_exp_f32 v121, v121
    v_exp_f32 v122, v122
    v_exp_f32 v123, v123
    v_sub_f32 v92, v92, v44
    v_sub_f32 v93, v93, v44
    v_sub_f32 v94, v94, v44
    v_sub_f32 v95, v95, v44
    v_sub_f32 v96, v96, v44
    v_sub_f32 v97, v97, v44
    v_sub_f32 v98, v98, v44
    v_sub_f32 v99, v99, v44
    v_sub_f32 v100, v100, v44
    v_sub_f32 v101, v101, v44
    v_sub_f32 v102, v102, v44
    v_sub_f32 v103, v103, v44
    v_sub_f32 v104, v104, v44
    v_sub_f32 v105, v105, v44
    v_sub_f32 v106, v106, v44
    v_sub_f32 v107, v107, v44
    v_exp_f32 v92, v92
    v_exp_f32 v93, v93
    v_smfmac_f32_32x32x32_bf16 v[76:91], v[24:27], v[116:123], v43
    s_mov_b64 exec, s[60:61]
    ds_read_b128 v[20:23], v2 offset:25600
    ds_read_b128 v[24:27], v2 offset:25344
    s_mov_b64 exec, -1
    v_exp_f32 v94, v94
    v_exp_f32 v95, v95
    v_exp_f32 v96, v96
    v_mfma_f32_32x32x16_bf16 v[108:123], v[16:19], v[8:11], 0
    ds_read_b128 v[12:15], v2 offset:24576
    s_waitcnt vmcnt(9)
    ds_read_b64_tr_b16 v[168:169], v41 offset:57344
    ds_read_b64_tr_b16 v[170:171], v41 offset:57600
    ds_read_b64_tr_b16 v[172:173], v42 offset:57344
    ds_read_b64_tr_b16 v[174:175], v42 offset:57600
    v_exp_f32 v97, v97
    v_exp_f32 v98, v98
    v_exp_f32 v99, v99
    v_exp_f32 v100, v100
    v_exp_f32 v101, v101
    v_smfmac_f32_32x32x32_bf16 v[60:75], v[28:31], v[92:99], v43
    v_exp_f32 v102, v102
    v_exp_f32 v103, v103
    v_exp_f32 v104, v104
    v_exp_f32 v105, v105
    v_exp_f32 v106, v106
    v_exp_f32 v107, v107
    v_sub_f32 v108, v108, v45
    v_sub_f32 v109, v109, v45
    v_sub_f32 v110, v110, v45
    v_sub_f32 v111, v111, v45
    v_sub_f32 v112, v112, v45
    v_sub_f32 v113, v113, v45
    v_sub_f32 v114, v114, v45
    v_sub_f32 v115, v115, v45
    v_sub_f32 v116, v116, v45
    v_sub_f32 v117, v117, v45
    v_sub_f32 v118, v118, v45
    v_sub_f32 v119, v119, v45
    v_sub_f32 v120, v120, v45
    v_sub_f32 v121, v121, v45
    v_sub_f32 v122, v122, v45
    v_sub_f32 v123, v123, v45
    v_exp_f32 v108, v108
    v_exp_f32 v109, v109
    v_smfmac_f32_32x32x32_bf16 v[60:75], v[32:35], v[100:107], v43
    v_exp_f32 v110, v110
    v_exp_f32 v111, v111
    v_exp_f32 v112, v112
    s_waitcnt lgkmcnt(0)
    v_mfma_f32_32x32x16_bf16 v[92:107], v[12:15], v[4:7], 0
    s_add_u32 m0, s10, 57344
    s_add_u32 s13, s11, 57344
    buffer_load_dwordx4 v3, s[52:55], s13 offen sc1 lds
    s_add_u32 m0, s10, 122880
    s_add_u32 s13, s11, 122880
    buffer_load_dwordx4 v3, s[52:55], s13 offen sc1 lds
    v_exp_f32 v113, v113
    v_exp_f32 v114, v114
    v_exp_f32 v115, v115
    v_exp_f32 v116, v116
    v_exp_f32 v117, v117
    v_smfmac_f32_32x32x32_bf16 v[76:91], v[28:31], v[108:115], v43
    v_exp_f32 v118, v118
    v_exp_f32 v119, v119
    v_exp_f32 v120, v120
    v_exp_f32 v121, v121
    v_exp_f32 v122, v122
    v_exp_f32 v123, v123
    v_sub_f32 v92, v92, v44
    v_sub_f32 v93, v93, v44
    v_sub_f32 v94, v94, v44
    v_sub_f32 v95, v95, v44
    v_sub_f32 v96, v96, v44
    v_sub_f32 v97, v97, v44
    v_sub_f32 v98, v98, v44
    v_sub_f32 v99, v99, v44
    v_sub_f32 v100, v100, v44
    v_sub_f32 v101, v101, v44
    v_sub_f32 v102, v102, v44
    v_sub_f32 v103, v103, v44
    v_sub_f32 v104, v104, v44
    v_sub_f32 v105, v105, v44
    v_sub_f32 v106, v106, v44
    v_sub_f32 v107, v107, v44
    v_exp_f32 v92, v92
    v_exp_f32 v93, v93
    v_smfmac_f32_32x32x32_bf16 v[76:91], v[32:35], v[116:123], v43
    s_mov_b64 exec, s[60:61]
    ds_read_b128 v[28:31], v2 offset:27648
    ds_read_b128 v[32:35], v2 offset:27392
    s_mov_b64 exec, -1
    v_exp_f32 v94, v94
    v_exp_f32 v95, v95
    v_exp_f32 v96, v96
    v_mfma_f32_32x32x16_bf16 v[108:123], v[12:15], v[8:11], 0
    ds_read_b128 v[16:19], v2 offset:26624
    s_waitcnt vmcnt(8)
    ds_read_b64_tr_b16 v[176:177], v124 offset:0
    ds_read_b64_tr_b16 v[178:179], v124 offset:256
    ds_read_b64_tr_b16 v[180:181], v124 offset:1024
    ds_read_b64_tr_b16 v[182:183], v124 offset:1280
    v_exp_f32 v97, v97
    v_exp_f32 v98, v98
    v_exp_f32 v99, v99
    v_exp_f32 v100, v100
    v_exp_f32 v101, v101
    v_smfmac_f32_32x32x32_bf16 v[60:75], v[20:23], v[92:99], v43
    v_exp_f32 v102, v102
    v_exp_f32 v103, v103
    v_exp_f32 v104, v104
    v_exp_f32 v105, v105
    v_exp_f32 v106, v106
    v_exp_f32 v107, v107
    v_sub_f32 v108, v108, v45
    v_sub_f32 v109, v109, v45
    v_sub_f32 v110, v110, v45
    v_sub_f32 v111, v111, v45
    v_sub_f32 v112, v112, v45
    v_sub_f32 v113, v113, v45
    v_sub_f32 v114, v114, v45
    v_sub_f32 v115, v115, v45
    v_sub_f32 v116, v116, v45
    v_sub_f32 v117, v117, v45
    v_sub_f32 v118, v118, v45
    v_sub_f32 v119, v119, v45
    v_sub_f32 v120, v120, v45
    v_sub_f32 v121, v121, v45
    v_sub_f32 v122, v122, v45
    v_sub_f32 v123, v123, v45
    v_exp_f32 v108, v108
    v_exp_f32 v109, v109
    v_smfmac_f32_32x32x32_bf16 v[60:75], v[24:27], v[100:107], v43
    v_exp_f32 v110, v110
    v_exp_f32 v111, v111
    v_exp_f32 v112, v112
    s_waitcnt lgkmcnt(0)
    v_mfma_f32_32x32x16_bf16 v[92:107], v[16:19], v[4:7], 0
    s_add_u32 m0, s66, 0
    s_add_u32 s13, s67, 88064
    buffer_load_dwordx4 v125, s[44:47], s13 offen lds
    s_add_u32 m0, s66, 1024
    s_add_u32 s13, s67, 264192
    buffer_load_dwordx4 v125, s[44:47], s13 offen lds
    v_exp_f32 v113, v113
    v_exp_f32 v114, v114
    v_exp_f32 v115, v115
    v_exp_f32 v116, v116
    v_exp_f32 v117, v117
    v_smfmac_f32_32x32x32_bf16 v[76:91], v[20:23], v[108:115], v43
    v_exp_f32 v118, v118
    v_exp_f32 v119, v119
    v_exp_f32 v120, v120
    v_exp_f32 v121, v121
    v_exp_f32 v122, v122
    v_exp_f32 v123, v123
    s_setprio 1
    v_sub_f32 v92, v92, v44
    v_sub_f32 v93, v93, v44
    v_sub_f32 v94, v94, v44
    v_sub_f32 v95, v95, v44
    v_sub_f32 v96, v96, v44
    v_sub_f32 v97, v97, v44
    v_sub_f32 v98, v98, v44
    v_sub_f32 v99, v99, v44
    v_sub_f32 v100, v100, v44
    v_sub_f32 v101, v101, v44
    v_sub_f32 v102, v102, v44
    v_sub_f32 v103, v103, v44
    v_sub_f32 v104, v104, v44
    v_sub_f32 v105, v105, v44
    v_sub_f32 v106, v106, v44
    v_sub_f32 v107, v107, v44
    v_exp_f32 v92, v92
    v_exp_f32 v93, v93
    v_smfmac_f32_32x32x32_bf16 v[76:91], v[24:27], v[116:123], v43
    s_mov_b64 exec, s[60:61]
    ds_read_b128 v[20:23], v2 offset:29696
    ds_read_b128 v[24:27], v2 offset:29440
    s_mov_b64 exec, -1
    v_exp_f32 v94, v94
    v_exp_f32 v95, v95
    v_exp_f32 v96, v96
    v_mfma_f32_32x32x16_bf16 v[108:123], v[16:19], v[8:11], 0
    ds_read_b128 v[12:15], v2 offset:28672
    s_waitcnt vmcnt(8)
    ds_read_b64_tr_b16 v[184:185], v124 offset:2048
    ds_read_b64_tr_b16 v[186:187], v124 offset:2304
    ds_read_b64_tr_b16 v[188:189], v124 offset:3072
    ds_read_b64_tr_b16 v[190:191], v124 offset:3328
    v_exp_f32 v97, v97
    v_exp_f32 v98, v98
    v_exp_f32 v99, v99
    v_exp_f32 v100, v100
    v_exp_f32 v101, v101
    v_smfmac_f32_32x32x32_bf16 v[60:75], v[28:31], v[92:99], v43
    v_exp_f32 v102, v102
    v_exp_f32 v103, v103
    v_exp_f32 v104, v104
    v_exp_f32 v105, v105
    v_exp_f32 v106, v106
    v_exp_f32 v107, v107
    v_sub_f32 v108, v108, v45
    v_sub_f32 v109, v109, v45
    v_sub_f32 v110, v110, v45
    v_sub_f32 v111, v111, v45
    v_sub_f32 v112, v112, v45
    v_sub_f32 v113, v113, v45
    v_sub_f32 v114, v114, v45
    v_sub_f32 v115, v115, v45
    v_sub_f32 v116, v116, v45
    v_sub_f32 v117, v117, v45
    v_sub_f32 v118, v118, v45
    v_sub_f32 v119, v119, v45
    v_sub_f32 v120, v120, v45
    v_sub_f32 v121, v121, v45
    v_sub_f32 v122, v122, v45
    v_sub_f32 v123, v123, v45
    v_exp_f32 v108, v108
    v_exp_f32 v109, v109
    v_smfmac_f32_32x32x32_bf16 v[60:75], v[32:35], v[100:107], v43
    v_exp_f32 v110, v110
    v_exp_f32 v111, v111
    v_exp_f32 v112, v112
    s_waitcnt lgkmcnt(0)
    v_mfma_f32_32x32x16_bf16 v[92:107], v[12:15], v[4:7], 0
    s_add_u32 m0, s66, 2048
    s_add_u32 s13, s67, 440320
    buffer_load_dwordx4 v125, s[44:47], s13 offen lds
    s_add_u32 m0, s66, 3072
    s_add_u32 s13, s67, 616448
    buffer_load_dwordx4 v125, s[44:47], s13 offen lds
    v_exp_f32 v113, v113
    v_exp_f32 v114, v114
    v_exp_f32 v115, v115
    v_exp_f32 v116, v116
    v_exp_f32 v117, v117
    v_smfmac_f32_32x32x32_bf16 v[76:91], v[28:31], v[108:115], v43
    v_exp_f32 v118, v118
    v_exp_f32 v119, v119
    v_exp_f32 v120, v120
    v_exp_f32 v121, v121
    v_exp_f32 v122, v122
    v_exp_f32 v123, v123
    v_sub_f32 v92, v92, v44
    v_sub_f32 v93, v93, v44
    v_sub_f32 v94, v94, v44
    v_sub_f32 v95, v95, v44
    v_sub_f32 v96, v96, v44
    v_sub_f32 v97, v97, v44
    v_sub_f32 v98, v98, v44
    v_sub_f32 v99, v99, v44
    v_sub_f32 v100, v100, v44
    v_sub_f32 v101, v101, v44
    v_sub_f32 v102, v102, v44
    v_sub_f32 v103, v103, v44
    v_sub_f32 v104, v104, v44
    v_sub_f32 v105, v105, v44
    v_sub_f32 v106, v106, v44
    v_sub_f32 v107, v107, v44
    v_exp_f32 v92, v92
    v_exp_f32 v93, v93
    v_smfmac_f32_32x32x32_bf16 v[76:91], v[32:35], v[116:123], v43
    s_mov_b64 exec, s[60:61]
    ds_read_b128 v[28:31], v2 offset:31744
    ds_read_b128 v[32:35], v2 offset:31488
    s_mov_b64 exec, -1
    buffer_load_dword v127, v3, s[52:55], s101 offen offset:1024 sc1
    s_add_u32 s13, s62, 0
    s_and_b32 s14, s13, 7
    s_lshr_b32 s13, s13, 3
    s_lshl_b32 s13, s13, 14
    s_lshl_b32 s14, s14, 7
    s_add_u32 s13, s13, s14
    buffer_load_dword v127, v126, s[56:59], s13 offen
    v_exp_f32 v94, v94
    v_exp_f32 v95, v95
    v_exp_f32 v96, v96
    v_mfma_f32_32x32x16_bf16 v[108:123], v[12:15], v[8:11], 0
    ds_read_b128 v[16:19], v2 offset:30720
    v_exp_f32 v97, v97
    v_exp_f32 v98, v98
    v_exp_f32 v99, v99
    v_exp_f32 v100, v100
    v_exp_f32 v101, v101
    v_smfmac_f32_32x32x32_bf16 v[60:75], v[20:23], v[92:99], v43
    v_exp_f32 v102, v102
    v_exp_f32 v103, v103
    v_exp_f32 v104, v104
    v_exp_f32 v105, v105
    v_exp_f32 v106, v106
    v_exp_f32 v107, v107
    s_setprio 0
    v_sub_f32 v108, v108, v45
    v_sub_f32 v109, v109, v45
    v_sub_f32 v110, v110, v45
    v_sub_f32 v111, v111, v45
    v_sub_f32 v112, v112, v45
    v_sub_f32 v113, v113, v45
    v_sub_f32 v114, v114, v45
    v_sub_f32 v115, v115, v45
    v_sub_f32 v116, v116, v45
    v_sub_f32 v117, v117, v45
    v_sub_f32 v118, v118, v45
    v_sub_f32 v119, v119, v45
    v_sub_f32 v120, v120, v45
    v_sub_f32 v121, v121, v45
    v_sub_f32 v122, v122, v45
    v_sub_f32 v123, v123, v45
    v_exp_f32 v108, v108
    v_exp_f32 v109, v109
    v_smfmac_f32_32x32x32_bf16 v[60:75], v[24:27], v[100:107], v43
    v_exp_f32 v110, v110
    v_exp_f32 v111, v111
    v_exp_f32 v112, v112
    s_waitcnt lgkmcnt(0)
    v_mfma_f32_32x32x16_bf16 v[92:107], v[16:19], v[4:7], 0
    v_exp_f32 v113, v113
    v_exp_f32 v114, v114
    v_exp_f32 v115, v115
    v_exp_f32 v116, v116
    v_exp_f32 v117, v117
    v_smfmac_f32_32x32x32_bf16 v[76:91], v[20:23], v[108:115], v43
    v_exp_f32 v118, v118
    v_exp_f32 v119, v119
    v_exp_f32 v120, v120
    v_exp_f32 v121, v121
    v_exp_f32 v122, v122
    v_exp_f32 v123, v123
    s_waitcnt vmcnt(6)
    s_barrier
    s_setprio 3
    v_sub_f32 v92, v92, v44
    v_sub_f32 v93, v93, v44
    v_sub_f32 v94, v94, v44
    v_sub_f32 v95, v95, v44
    v_sub_f32 v96, v96, v44
    v_sub_f32 v97, v97, v44
    v_sub_f32 v98, v98, v44
    v_sub_f32 v99, v99, v44
    v_sub_f32 v100, v100, v44
    v_sub_f32 v101, v101, v44
    v_sub_f32 v102, v102, v44
    v_sub_f32 v103, v103, v44
    v_sub_f32 v104, v104, v44
    v_sub_f32 v105, v105, v44
    v_sub_f32 v106, v106, v44
    v_sub_f32 v107, v107, v44
    v_exp_f32 v92, v92
    v_exp_f32 v93, v93
    v_smfmac_f32_32x32x32_bf16 v[76:91], v[24:27], v[116:123], v43
    s_mov_b64 exec, s[60:61]
    ds_read_b128 v[20:23], v2 offset:33792
    ds_read_b128 v[24:27], v2 offset:33536
    s_mov_b64 exec, -1
    v_exp_f32 v94, v94
    v_exp_f32 v95, v95
    v_exp_f32 v96, v96
    v_mfma_f32_32x32x16_bf16 v[108:123], v[16:19], v[8:11], 0
    ds_read_b128 v[12:15], v2 offset:32768
    v_exp_f32 v97, v97
    v_exp_f32 v98, v98
    v_exp_f32 v99, v99
    v_exp_f32 v100, v100
    v_exp_f32 v101, v101
    v_smfmac_f32_32x32x32_bf16 v[60:75], v[28:31], v[92:99], v43
    v_exp_f32 v102, v102
    v_exp_f32 v103, v103
    v_exp_f32 v104, v104
    v_exp_f32 v105, v105
    v_exp_f32 v106, v106
    v_exp_f32 v107, v107
    v_sub_f32 v108, v108, v45
    v_sub_f32 v109, v109, v45
    v_sub_f32 v110, v110, v45
    v_sub_f32 v111, v111, v45
    v_sub_f32 v112, v112, v45
    v_sub_f32 v113, v113, v45
    v_sub_f32 v114, v114, v45
    v_sub_f32 v115, v115, v45
    v_sub_f32 v116, v116, v45
    v_sub_f32 v117, v117, v45
    v_sub_f32 v118, v118, v45
    v_sub_f32 v119, v119, v45
    v_sub_f32 v120, v120, v45
    v_sub_f32 v121, v121, v45
    v_sub_f32 v122, v122, v45
    v_sub_f32 v123, v123, v45
    v_exp_f32 v108, v108
    v_exp_f32 v109, v109
    v_smfmac_f32_32x32x32_bf16 v[60:75], v[32:35], v[100:107], v43
    v_exp_f32 v110, v110
    v_exp_f32 v111, v111
    v_exp_f32 v112, v112
    s_waitcnt lgkmcnt(0)
    v_mfma_f32_32x32x16_bf16 v[92:107], v[12:15], v[4:7], 0
    s_add_u32 m0, s10, 0
    s_add_u32 s13, s67, 792576
    buffer_load_dwordx4 v125, s[44:47], s13 offen lds
    s_add_u32 m0, s10, 16384
    s_add_u32 s13, s67, 968704
    buffer_load_dwordx4 v125, s[44:47], s13 offen lds
    v_exp_f32 v113, v113
    v_exp_f32 v114, v114
    v_exp_f32 v115, v115
    v_exp_f32 v116, v116
    v_exp_f32 v117, v117
    v_smfmac_f32_32x32x32_bf16 v[76:91], v[28:31], v[108:115], v43
    v_exp_f32 v118, v118
    v_exp_f32 v119, v119
    v_exp_f32 v120, v120
    v_exp_f32 v121, v121
    v_exp_f32 v122, v122
    v_exp_f32 v123, v123
    v_sub_f32 v92, v92, v44
    v_sub_f32 v93, v93, v44
    v_sub_f32 v94, v94, v44
    v_sub_f32 v95, v95, v44
    v_sub_f32 v96, v96, v44
    v_sub_f32 v97, v97, v44
    v_sub_f32 v98, v98, v44
    v_sub_f32 v99, v99, v44
    v_sub_f32 v100, v100, v44
    v_sub_f32 v101, v101, v44
    v_sub_f32 v102, v102, v44
    v_sub_f32 v103, v103, v44
    v_sub_f32 v104, v104, v44
    v_sub_f32 v105, v105, v44
    v_sub_f32 v106, v106, v44
    v_sub_f32 v107, v107, v44
    v_exp_f32 v92, v92
    v_exp_f32 v93, v93
    v_smfmac_f32_32x32x32_bf16 v[76:91], v[32:35], v[116:123], v43
    s_mov_b64 exec, s[60:61]
    ds_read_b128 v[28:31], v2 offset:35840
    ds_read_b128 v[32:35], v2 offset:35584
    s_mov_b64 exec, -1
    v_exp_f32 v94, v94
    v_exp_f32 v95, v95
    v_exp_f32 v96, v96
    v_mfma_f32_32x32x16_bf16 v[108:123], v[12:15], v[8:11], 0
    ds_read_b128 v[16:19], v2 offset:34816
    v_exp_f32 v97, v97
    v_exp_f32 v98, v98
    v_exp_f32 v99, v99
    v_exp_f32 v100, v100
    v_exp_f32 v101, v101
    v_smfmac_f32_32x32x32_bf16 v[60:75], v[20:23], v[92:99], v43
    v_exp_f32 v102, v102
    v_exp_f32 v103, v103
    v_exp_f32 v104, v104
    v_exp_f32 v105, v105
    v_exp_f32 v106, v106
    v_exp_f32 v107, v107
    v_sub_f32 v108, v108, v45
    v_sub_f32 v109, v109, v45
    v_sub_f32 v110, v110, v45
    v_sub_f32 v111, v111, v45
    v_sub_f32 v112, v112, v45
    v_sub_f32 v113, v113, v45
    v_sub_f32 v114, v114, v45
    v_sub_f32 v115, v115, v45
    v_sub_f32 v116, v116, v45
    v_sub_f32 v117, v117, v45
    v_sub_f32 v118, v118, v45
    v_sub_f32 v119, v119, v45
    v_sub_f32 v120, v120, v45
    v_sub_f32 v121, v121, v45
    v_sub_f32 v122, v122, v45
    v_sub_f32 v123, v123, v45
    v_exp_f32 v108, v108
    v_exp_f32 v109, v109
    v_smfmac_f32_32x32x32_bf16 v[60:75], v[24:27], v[100:107], v43
    v_exp_f32 v110, v110
    v_exp_f32 v111, v111
    v_exp_f32 v112, v112
    s_waitcnt lgkmcnt(0)
    v_mfma_f32_32x32x16_bf16 v[92:107], v[16:19], v[4:7], 0
    s_add_u32 m0, s10, 8192
    s_add_u32 s13, s67, 1144832
    buffer_load_dwordx4 v125, s[44:47], s13 offen lds
    s_add_u32 m0, s10, 24576
    s_add_u32 s13, s67, 1320960
    buffer_load_dwordx4 v125, s[44:47], s13 offen lds
    v_exp_f32 v113, v113
    v_exp_f32 v114, v114
    v_exp_f32 v115, v115
    v_exp_f32 v116, v116
    v_exp_f32 v117, v117
    v_smfmac_f32_32x32x32_bf16 v[76:91], v[20:23], v[108:115], v43
    v_exp_f32 v118, v118
    v_exp_f32 v119, v119
    v_exp_f32 v120, v120
    v_exp_f32 v121, v121
    v_exp_f32 v122, v122
    v_exp_f32 v123, v123
    v_sub_f32 v92, v92, v44
    v_sub_f32 v93, v93, v44
    v_sub_f32 v94, v94, v44
    v_sub_f32 v95, v95, v44
    v_sub_f32 v96, v96, v44
    v_sub_f32 v97, v97, v44
    v_sub_f32 v98, v98, v44
    v_sub_f32 v99, v99, v44
    v_sub_f32 v100, v100, v44
    v_sub_f32 v101, v101, v44
    v_sub_f32 v102, v102, v44
    v_sub_f32 v103, v103, v44
    v_sub_f32 v104, v104, v44
    v_sub_f32 v105, v105, v44
    v_sub_f32 v106, v106, v44
    v_sub_f32 v107, v107, v44
    v_exp_f32 v92, v92
    v_exp_f32 v93, v93
    v_smfmac_f32_32x32x32_bf16 v[76:91], v[24:27], v[116:123], v43
    s_mov_b64 exec, s[60:61]
    ds_read_b128 v[20:23], v2 offset:37888
    ds_read_b128 v[24:27], v2 offset:37632
    s_mov_b64 exec, -1
    v_exp_f32 v94, v94
    v_exp_f32 v95, v95
    v_exp_f32 v96, v96
    v_mfma_f32_32x32x16_bf16 v[108:123], v[16:19], v[8:11], 0
    ds_read_b128 v[12:15], v2 offset:36864
    s_waitcnt vmcnt(8)
    ds_read_b64_tr_b16 v[192:193], v124 offset:0
    ds_read_b64_tr_b16 v[194:195], v124 offset:256
    ds_read_b64_tr_b16 v[196:197], v124 offset:1024
    ds_read_b64_tr_b16 v[198:199], v124 offset:1280
    v_exp_f32 v97, v97
    v_exp_f32 v98, v98
    v_exp_f32 v99, v99
    v_exp_f32 v100, v100
    v_exp_f32 v101, v101
    v_smfmac_f32_32x32x32_bf16 v[60:75], v[28:31], v[92:99], v43
    v_exp_f32 v102, v102
    v_exp_f32 v103, v103
    v_exp_f32 v104, v104
    v_exp_f32 v105, v105
    v_exp_f32 v106, v106
    v_exp_f32 v107, v107
    v_sub_f32 v108, v108, v45
    v_sub_f32 v109, v109, v45
    v_sub_f32 v110, v110, v45
    v_sub_f32 v111, v111, v45
    v_sub_f32 v112, v112, v45
    v_sub_f32 v113, v113, v45
    v_sub_f32 v114, v114, v45
    v_sub_f32 v115, v115, v45
    v_sub_f32 v116, v116, v45
    v_sub_f32 v117, v117, v45
    v_sub_f32 v118, v118, v45
    v_sub_f32 v119, v119, v45
    v_sub_f32 v120, v120, v45
    v_sub_f32 v121, v121, v45
    v_sub_f32 v122, v122, v45
    v_sub_f32 v123, v123, v45
    v_exp_f32 v108, v108
    v_exp_f32 v109, v109
    v_smfmac_f32_32x32x32_bf16 v[60:75], v[32:35], v[100:107], v43
    v_exp_f32 v110, v110
    v_exp_f32 v111, v111
    v_exp_f32 v112, v112
    s_waitcnt lgkmcnt(0)
    v_mfma_f32_32x32x16_bf16 v[92:107], v[12:15], v[4:7], 0
    s_add_u32 m0, s10, 65536
    s_add_u32 s13, s67, 132096
    buffer_load_dwordx4 v125, s[44:47], s13 offen lds
    s_add_u32 m0, s10, 81920
    s_add_u32 s13, s67, 308224
    buffer_load_dwordx4 v125, s[44:47], s13 offen lds
    v_exp_f32 v113, v113
    v_exp_f32 v114, v114
    v_exp_f32 v115, v115
    v_exp_f32 v116, v116
    v_exp_f32 v117, v117
    v_smfmac_f32_32x32x32_bf16 v[76:91], v[28:31], v[108:115], v43
    v_exp_f32 v118, v118
    v_exp_f32 v119, v119
    v_exp_f32 v120, v120
    v_exp_f32 v121, v121
    v_exp_f32 v122, v122
    v_exp_f32 v123, v123
    v_sub_f32 v92, v92, v44
    v_sub_f32 v93, v93, v44
    v_sub_f32 v94, v94, v44
    v_sub_f32 v95, v95, v44
    v_sub_f32 v96, v96, v44
    v_sub_f32 v97, v97, v44
    v_sub_f32 v98, v98, v44
    v_sub_f32 v99, v99, v44
    v_sub_f32 v100, v100, v44
    v_sub_f32 v101, v101, v44
    v_sub_f32 v102, v102, v44
    v_sub_f32 v103, v103, v44
    v_sub_f32 v104, v104, v44
    v_sub_f32 v105, v105, v44
    v_sub_f32 v106, v106, v44
    v_sub_f32 v107, v107, v44
    v_exp_f32 v92, v92
    v_exp_f32 v93, v93
    v_smfmac_f32_32x32x32_bf16 v[76:91], v[32:35], v[116:123], v43
    s_mov_b64 exec, s[60:61]
    ds_read_b128 v[28:31], v2 offset:39936
    ds_read_b128 v[32:35], v2 offset:39680
    s_mov_b64 exec, -1
    v_exp_f32 v94, v94
    v_exp_f32 v95, v95
    v_exp_f32 v96, v96
    v_mfma_f32_32x32x16_bf16 v[108:123], v[12:15], v[8:11], 0
    ds_read_b128 v[16:19], v2 offset:38912
    s_waitcnt vmcnt(8)
    ds_read_b64_tr_b16 v[200:201], v124 offset:2048
    ds_read_b64_tr_b16 v[202:203], v124 offset:2304
    ds_read_b64_tr_b16 v[204:205], v124 offset:3072
    ds_read_b64_tr_b16 v[206:207], v124 offset:3328
    v_exp_f32 v97, v97
    v_exp_f32 v98, v98
    v_exp_f32 v99, v99
    v_exp_f32 v100, v100
    v_exp_f32 v101, v101
    v_smfmac_f32_32x32x32_bf16 v[60:75], v[20:23], v[92:99], v43
    v_exp_f32 v102, v102
    v_exp_f32 v103, v103
    v_exp_f32 v104, v104
    v_exp_f32 v105, v105
    v_exp_f32 v106, v106
    v_exp_f32 v107, v107
    v_sub_f32 v108, v108, v45
    v_sub_f32 v109, v109, v45
    v_sub_f32 v110, v110, v45
    v_sub_f32 v111, v111, v45
    v_sub_f32 v112, v112, v45
    v_sub_f32 v113, v113, v45
    v_sub_f32 v114, v114, v45
    v_sub_f32 v115, v115, v45
    v_sub_f32 v116, v116, v45
    v_sub_f32 v117, v117, v45
    v_sub_f32 v118, v118, v45
    v_sub_f32 v119, v119, v45
    v_sub_f32 v120, v120, v45
    v_sub_f32 v121, v121, v45
    v_sub_f32 v122, v122, v45
    v_sub_f32 v123, v123, v45
    v_exp_f32 v108, v108
    v_exp_f32 v109, v109
    v_smfmac_f32_32x32x32_bf16 v[60:75], v[24:27], v[100:107], v43
    v_exp_f32 v110, v110
    v_exp_f32 v111, v111
    v_exp_f32 v112, v112
    s_waitcnt lgkmcnt(0)
    v_mfma_f32_32x32x16_bf16 v[92:107], v[16:19], v[4:7], 0
    s_add_u32 m0, s10, 73728
    s_add_u32 s13, s67, 484352
    buffer_load_dwordx4 v125, s[44:47], s13 offen lds
    s_add_u32 m0, s10, 90112
    s_add_u32 s13, s67, 660480
    buffer_load_dwordx4 v125, s[44:47], s13 offen lds
    v_exp_f32 v113, v113
    v_exp_f32 v114, v114
    v_exp_f32 v115, v115
    v_exp_f32 v116, v116
    v_exp_f32 v117, v117
    v_smfmac_f32_32x32x32_bf16 v[76:91], v[20:23], v[108:115], v43
    v_exp_f32 v118, v118
    v_exp_f32 v119, v119
    v_exp_f32 v120, v120
    v_exp_f32 v121, v121
    v_exp_f32 v122, v122
    v_exp_f32 v123, v123
    v_sub_f32 v92, v92, v44
    v_sub_f32 v93, v93, v44
    v_sub_f32 v94, v94, v44
    v_sub_f32 v95, v95, v44
    v_sub_f32 v96, v96, v44
    v_sub_f32 v97, v97, v44
    v_sub_f32 v98, v98, v44
    v_sub_f32 v99, v99, v44
    v_sub_f32 v100, v100, v44
    v_sub_f32 v101, v101, v44
    v_sub_f32 v102, v102, v44
    v_sub_f32 v103, v103, v44
    v_sub_f32 v104, v104, v44
    v_sub_f32 v105, v105, v44
    v_sub_f32 v106, v106, v44
    v_sub_f32 v107, v107, v44
    v_exp_f32 v92, v92
    v_exp_f32 v93, v93
    v_smfmac_f32_32x32x32_bf16 v[76:91], v[24:27], v[116:123], v43
    s_mov_b64 exec, s[60:61]
    ds_read_b128 v[20:23], v2 offset:41984
    ds_read_b128 v[24:27], v2 offset:41728
    s_mov_b64 exec, -1
    v_exp_f32 v94, v94
    v_exp_f32 v95, v95
    v_exp_f32 v96, v96
    v_mfma_f32_32x32x16_bf16 v[108:123], v[16:19], v[8:11], 0
    ds_read_b128 v[12:15], v2 offset:40960
    v_exp_f32 v97, v97
    v_exp_f32 v98, v98
    v_exp_f32 v99, v99
    v_exp_f32 v100, v100
    v_exp_f32 v101, v101
    v_smfmac_f32_32x32x32_bf16 v[60:75], v[28:31], v[92:99], v43
    v_exp_f32 v102, v102
    v_exp_f32 v103, v103
    v_exp_f32 v104, v104
    v_exp_f32 v105, v105
    v_exp_f32 v106, v106
    v_exp_f32 v107, v107
    v_sub_f32 v108, v108, v45
    v_sub_f32 v109, v109, v45
    v_sub_f32 v110, v110, v45
    v_sub_f32 v111, v111, v45
    v_sub_f32 v112, v112, v45
    v_sub_f32 v113, v113, v45
    v_sub_f32 v114, v114, v45
    v_sub_f32 v115, v115, v45
    v_sub_f32 v116, v116, v45
    v_sub_f32 v117, v117, v45
    v_sub_f32 v118, v118, v45
    v_sub_f32 v119, v119, v45
    v_sub_f32 v120, v120, v45
    v_sub_f32 v121, v121, v45
    v_sub_f32 v122, v122, v45
    v_sub_f32 v123, v123, v45
    v_exp_f32 v108, v108
    v_exp_f32 v109, v109
    v_smfmac_f32_32x32x32_bf16 v[60:75], v[32:35], v[100:107], v43
    v_exp_f32 v110, v110
    v_exp_f32 v111, v111
    v_exp_f32 v112, v112
    s_waitcnt lgkmcnt(0)
    v_mfma_f32_32x32x16_bf16 v[92:107], v[12:15], v[4:7], 0
    s_add_u32 m0, s66, 0
    s_add_u32 s13, s67, 836608
    buffer_load_dwordx4 v125, s[44:47], s13 offen lds
    s_add_u32 m0, s66, 1024
    s_add_u32 s13, s67, 1012736
    buffer_load_dwordx4 v125, s[44:47], s13 offen lds
    v_exp_f32 v113, v113
    v_exp_f32 v114, v114
    v_exp_f32 v115, v115
    v_exp_f32 v116, v116
    v_exp_f32 v117, v117
    v_smfmac_f32_32x32x32_bf16 v[76:91], v[28:31], v[108:115], v43
    v_exp_f32 v118, v118
    v_exp_f32 v119, v119
    v_exp_f32 v120, v120
    v_exp_f32 v121, v121
    v_exp_f32 v122, v122
    v_exp_f32 v123, v123
    v_sub_f32 v92, v92, v44
    v_sub_f32 v93, v93, v44
    v_sub_f32 v94, v94, v44
    v_sub_f32 v95, v95, v44
    v_sub_f32 v96, v96, v44
    v_sub_f32 v97, v97, v44
    v_sub_f32 v98, v98, v44
    v_sub_f32 v99, v99, v44
    v_sub_f32 v100, v100, v44
    v_sub_f32 v101, v101, v44
    v_sub_f32 v102, v102, v44
    v_sub_f32 v103, v103, v44
    v_sub_f32 v104, v104, v44
    v_sub_f32 v105, v105, v44
    v_sub_f32 v106, v106, v44
    v_sub_f32 v107, v107, v44
    v_exp_f32 v92, v92
    v_exp_f32 v93, v93
    v_smfmac_f32_32x32x32_bf16 v[76:91], v[32:35], v[116:123], v43
    s_mov_b64 exec, s[60:61]
    ds_read_b128 v[28:31], v2 offset:44032
    ds_read_b128 v[32:35], v2 offset:43776
    s_mov_b64 exec, -1
    v_exp_f32 v94, v94
    v_exp_f32 v95, v95
    v_exp_f32 v96, v96
    v_mfma_f32_32x32x16_bf16 v[108:123], v[12:15], v[8:11], 0
    ds_read_b128 v[16:19], v2 offset:43008
    s_waitcnt vmcnt(8)
    ds_read_b64_tr_b16 v[208:209], v41 offset:0
    ds_read_b64_tr_b16 v[210:211], v41 offset:256
    ds_read_b64_tr_b16 v[212:213], v41 offset:16384
    ds_read_b64_tr_b16 v[214:215], v41 offset:16640
    v_exp_f32 v97, v97
    v_exp_f32 v98, v98
    v_exp_f32 v99, v99
    v_exp_f32 v100, v100
    v_exp_f32 v101, v101
    v_smfmac_f32_32x32x32_bf16 v[60:75], v[20:23], v[92:99], v43
    v_exp_f32 v102, v102
    v_exp_f32 v103, v103
    v_exp_f32 v104, v104
    v_exp_f32 v105, v105
    v_exp_f32 v106, v106
    v_exp_f32 v107, v107
    v_sub_f32 v108, v108, v45
    v_sub_f32 v109, v109, v45
    v_sub_f32 v110, v110, v45
    v_sub_f32 v111, v111, v45
    v_sub_f32 v112, v112, v45
    v_sub_f32 v113, v113, v45
    v_sub_f32 v114, v114, v45
    v_sub_f32 v115, v115, v45
    v_sub_f32 v116, v116, v45
    v_sub_f32 v117, v117, v45
    v_sub_f32 v118, v118, v45
    v_sub_f32 v119, v119, v45
    v_sub_f32 v120, v120, v45
    v_sub_f32 v121, v121, v45
    v_sub_f32 v122, v122, v45
    v_sub_f32 v123, v123, v45
    v_exp_f32 v108, v108
    v_exp_f32 v109, v109
    v_smfmac_f32_32x32x32_bf16 v[60:75], v[24:27], v[100:107], v43
    v_exp_f32 v110, v110
    v_exp_f32 v111, v111
    v_exp_f32 v112, v112
    s_waitcnt lgkmcnt(0)
    v_mfma_f32_32x32x16_bf16 v[92:107], v[16:19], v[4:7], 0
    s_add_u32 m0, s10, 0
    s_add_u32 s13, s67, 1188864
    buffer_load_dwordx4 v125, s[44:47], s13 offen lds
    s_add_u32 m0, s10, 16384
    s_add_u32 s13, s67, 1364992
    buffer_load_dwordx4 v125, s[44:47], s13 offen lds
    v_exp_f32 v113, v113
    v_exp_f32 v114, v114
    v_exp_f32 v115, v115
    v_exp_f32 v116, v116
    v_exp_f32 v117, v117
    v_smfmac_f32_32x32x32_bf16 v[76:91], v[20:23], v[108:115], v43
    v_exp_f32 v118, v118
    v_exp_f32 v119, v119
    v_exp_f32 v120, v120
    v_exp_f32 v121, v121
    v_exp_f32 v122, v122
    v_exp_f32 v123, v123
    v_sub_f32 v92, v92, v44
    v_sub_f32 v93, v93, v44
    v_sub_f32 v94, v94, v44
    v_sub_f32 v95, v95, v44
    v_sub_f32 v96, v96, v44
    v_sub_f32 v97, v97, v44
    v_sub_f32 v98, v98, v44
    v_sub_f32 v99, v99, v44
    v_sub_f32 v100, v100, v44
    v_sub_f32 v101, v101, v44
    v_sub_f32 v102, v102, v44
    v_sub_f32 v103, v103, v44
    v_sub_f32 v104, v104, v44
    v_sub_f32 v105, v105, v44
    v_sub_f32 v106, v106, v44
    v_sub_f32 v107, v107, v44
    v_exp_f32 v92, v92
    v_exp_f32 v93, v93
    v_smfmac_f32_32x32x32_bf16 v[76:91], v[24:27], v[116:123], v43
    s_mov_b64 exec, s[60:61]
    ds_read_b128 v[20:23], v2 offset:46080
    ds_read_b128 v[24:27], v2 offset:45824
    s_mov_b64 exec, -1
    v_exp_f32 v94, v94
    v_exp_f32 v95, v95
    v_exp_f32 v96, v96
    v_mfma_f32_32x32x16_bf16 v[108:123], v[16:19], v[8:11], 0
    ds_read_b128 v[12:15], v2 offset:45056
    s_waitcnt vmcnt(8)
    ds_read_b64_tr_b16 v[216:217], v41 offset:8192
    ds_read_b64_tr_b16 v[218:219], v41 offset:8448
    ds_read_b64_tr_b16 v[220:221], v41 offset:24576
    ds_read_b64_tr_b16 v[222:223], v41 offset:24832
    v_exp_f32 v97, v97
    v_exp_f32 v98, v98
    v_exp_f32 v99, v99
    v_exp_f32 v100, v100
    v_exp_f32 v101, v101
    v_smfmac_f32_32x32x32_bf16 v[60:75], v[28:31], v[92:99], v43
    v_exp_f32 v102, v102
    v_exp_f32 v103, v103
    v_exp_f32 v104, v104
    v_exp_f32 v105, v105
    v_exp_f32 v106, v106
    v_exp_f32 v107, v107
    v_sub_f32 v108, v108, v45
    v_sub_f32 v109, v109, v45
    v_sub_f32 v110, v110, v45
    v_sub_f32 v111, v111, v45
    v_sub_f32 v112, v112, v45
    v_sub_f32 v113, v113, v45
    v_sub_f32 v114, v114, v45
    v_sub_f32 v115, v115, v45
    v_sub_f32 v116, v116, v45
    v_sub_f32 v117, v117, v45
    v_sub_f32 v118, v118, v45
    v_sub_f32 v119, v119, v45
    v_sub_f32 v120, v120, v45
    v_sub_f32 v121, v121, v45
    v_sub_f32 v122, v122, v45
    v_sub_f32 v123, v123, v45
    v_exp_f32 v108, v108
    v_exp_f32 v109, v109
    v_smfmac_f32_32x32x32_bf16 v[60:75], v[32:35], v[100:107], v43
    v_exp_f32 v110, v110
    v_exp_f32 v111, v111
    v_exp_f32 v112, v112
    s_waitcnt lgkmcnt(0)
    v_mfma_f32_32x32x16_bf16 v[92:107], v[12:15], v[4:7], 0
    s_add_u32 m0, s10, 8192
    s_add_u32 s13, s69, 131072
    buffer_load_dwordx4 v126, s[48:51], s13 offen lds
    s_add_u32 m0, s10, 24576
    s_add_u32 s13, s69, 131136
    buffer_load_dwordx4 v126, s[48:51], s13 offen lds
    v_exp_f32 v113, v113
    v_exp_f32 v114, v114
    v_exp_f32 v115, v115
    v_exp_f32 v116, v116
    v_exp_f32 v117, v117
    v_smfmac_f32_32x32x32_bf16 v[76:91], v[28:31], v[108:115], v43
    v_exp_f32 v118, v118
    v_exp_f32 v119, v119
    v_exp_f32 v120, v120
    v_exp_f32 v121, v121
    v_exp_f32 v122, v122
    v_exp_f32 v123, v123
    v_sub_f32 v92, v92, v44
    v_sub_f32 v93, v93, v44
    v_sub_f32 v94, v94, v44
    v_sub_f32 v95, v95, v44
    v_sub_f32 v96, v96, v44
    v_sub_f32 v97, v97, v44
    v_sub_f32 v98, v98, v44
    v_sub_f32 v99, v99, v44
    v_sub_f32 v100, v100, v44
    v_sub_f32 v101, v101, v44
    v_sub_f32 v102, v102, v44
    v_sub_f32 v103, v103, v44
    v_sub_f32 v104, v104, v44
    v_sub_f32 v105, v105, v44
    v_sub_f32 v106, v106, v44
    v_sub_f32 v107, v107, v44
    v_exp_f32 v92, v92
    v_exp_f32 v93, v93
    v_smfmac_f32_32x32x32_bf16 v[76:91], v[32:35], v[116:123], v43
    s_mov_b64 exec, s[60:61]
    ds_read_b128 v[28:31], v2 offset:48128
    ds_read_b128 v[32:35], v2 offset:47872
    s_mov_b64 exec, -1
    v_exp_f32 v94, v94
    v_exp_f32 v95, v95
    v_exp_f32 v96, v96
    v_mfma_f32_32x32x16_bf16 v[108:123], v[12:15], v[8:11], 0
    ds_read_b128 v[16:19], v2 offset:47104
    s_waitcnt vmcnt(8)
    ds_read_b64_tr_b16 v[224:225], v42 offset:0
    ds_read_b64_tr_b16 v[226:227], v42 offset:256
    ds_read_b64_tr_b16 v[228:229], v42 offset:16384
    ds_read_b64_tr_b16 v[230:231], v42 offset:16640
    v_exp_f32 v97, v97
    v_exp_f32 v98, v98
    v_exp_f32 v99, v99
    v_exp_f32 v100, v100
    v_exp_f32 v101, v101
    v_smfmac_f32_32x32x32_bf16 v[60:75], v[20:23], v[92:99], v43
    v_exp_f32 v102, v102
    v_exp_f32 v103, v103
    v_exp_f32 v104, v104
    v_exp_f32 v105, v105
    v_exp_f32 v106, v106
    v_exp_f32 v107, v107
    v_sub_f32 v108, v108, v45
    v_sub_f32 v109, v109, v45
    v_sub_f32 v110, v110, v45
    v_sub_f32 v111, v111, v45
    v_sub_f32 v112, v112, v45
    v_sub_f32 v113, v113, v45
    v_sub_f32 v114, v114, v45
    v_sub_f32 v115, v115, v45
    v_sub_f32 v116, v116, v45
    v_sub_f32 v117, v117, v45
    v_sub_f32 v118, v118, v45
    v_sub_f32 v119, v119, v45
    v_sub_f32 v120, v120, v45
    v_sub_f32 v121, v121, v45
    v_sub_f32 v122, v122, v45
    v_sub_f32 v123, v123, v45
    v_exp_f32 v108, v108
    v_exp_f32 v109, v109
    v_smfmac_f32_32x32x32_bf16 v[60:75], v[24:27], v[100:107], v43
    v_exp_f32 v110, v110
    v_exp_f32 v111, v111
    v_exp_f32 v112, v112
    s_waitcnt lgkmcnt(0)
    v_mfma_f32_32x32x16_bf16 v[92:107], v[16:19], v[4:7], 0
    s_add_u32 m0, s10, 65536
    s_add_u32 s13, s69, 262144
    buffer_load_dwordx4 v126, s[48:51], s13 offen lds
    s_add_u32 m0, s10, 81920
    s_add_u32 s13, s69, 262208
    buffer_load_dwordx4 v126, s[48:51], s13 offen lds
    v_exp_f32 v113, v113
    v_exp_f32 v114, v114
    v_exp_f32 v115, v115
    v_exp_f32 v116, v116
    v_exp_f32 v117, v117
    v_smfmac_f32_32x32x32_bf16 v[76:91], v[20:23], v[108:115], v43
    v_exp_f32 v118, v118
    v_exp_f32 v119, v119
    v_exp_f32 v120, v120
    v_exp_f32 v121, v121
    v_exp_f32 v122, v122
    v_exp_f32 v123, v123
    v_sub_f32 v92, v92, v44
    v_sub_f32 v93, v93, v44
    v_sub_f32 v94, v94, v44
    v_sub_f32 v95, v95, v44
    v_sub_f32 v96, v96, v44
    v_sub_f32 v97, v97, v44
    v_sub_f32 v98, v98, v44
    v_sub_f32 v99, v99, v44
    v_sub_f32 v100, v100, v44
    v_sub_f32 v101, v101, v44
    v_sub_f32 v102, v102, v44
    v_sub_f32 v103, v103, v44
    v_sub_f32 v104, v104, v44
    v_sub_f32 v105, v105, v44
    v_sub_f32 v106, v106, v44
    v_sub_f32 v107, v107, v44
    v_exp_f32 v92, v92
    v_exp_f32 v93, v93
    v_smfmac_f32_32x32x32_bf16 v[76:91], v[24:27], v[116:123], v43
    s_mov_b64 exec, s[60:61]
    ds_read_b128 v[20:23], v2 offset:50176
    ds_read_b128 v[24:27], v2 offset:49920
    s_mov_b64 exec, -1
    v_exp_f32 v94, v94
    v_exp_f32 v95, v95
    v_exp_f32 v96, v96
    v_mfma_f32_32x32x16_bf16 v[108:123], v[16:19], v[8:11], 0
    ds_read_b128 v[12:15], v2 offset:49152
    s_waitcnt vmcnt(8)
    ds_read_b64_tr_b16 v[232:233], v42 offset:8192
    ds_read_b64_tr_b16 v[234:235], v42 offset:8448
    ds_read_b64_tr_b16 v[236:237], v42 offset:24576
    ds_read_b64_tr_b16 v[238:239], v42 offset:24832
    v_exp_f32 v97, v97
    v_exp_f32 v98, v98
    v_exp_f32 v99, v99
    v_exp_f32 v100, v100
    v_exp_f32 v101, v101
    v_smfmac_f32_32x32x32_bf16 v[60:75], v[28:31], v[92:99], v43
    v_exp_f32 v102, v102
    v_exp_f32 v103, v103
    v_exp_f32 v104, v104
    v_exp_f32 v105, v105
    v_exp_f32 v106, v106
    v_exp_f32 v107, v107
    s_setprio 2
    v_sub_f32 v108, v108, v45
    v_sub_f32 v109, v109, v45
    v_sub_f32 v110, v110, v45
    v_sub_f32 v111, v111, v45
    v_sub_f32 v112, v112, v45
    v_sub_f32 v113, v113, v45
    v_sub_f32 v114, v114, v45
    v_sub_f32 v115, v115, v45
    v_sub_f32 v116, v116, v45
    v_sub_f32 v117, v117, v45
    v_sub_f32 v118, v118, v45
    v_sub_f32 v119, v119, v45
    v_sub_f32 v120, v120, v45
    v_sub_f32 v121, v121, v45
    v_sub_f32 v122, v122, v45
    v_sub_f32 v123, v123, v45
    v_exp_f32 v108, v108
    v_exp_f32 v109, v109
    v_smfmac_f32_32x32x32_bf16 v[60:75], v[32:35], v[100:107], v43
    v_exp_f32 v110, v110
    v_exp_f32 v111, v111
    v_exp_f32 v112, v112
    s_waitcnt lgkmcnt(0)
    v_mfma_f32_32x32x16_bf16 v[92:107], v[12:15], v[4:7], 0
    s_add_u32 m0, s10, 73728
    s_add_u32 s13, s69, 393216
    buffer_load_dwordx4 v126, s[48:51], s13 offen lds
    s_add_u32 m0, s10, 90112
    s_add_u32 s13, s69, 393280
    buffer_load_dwordx4 v126, s[48:51], s13 offen lds
    v_exp_f32 v113, v113
    v_exp_f32 v114, v114
    v_exp_f32 v115, v115
    v_exp_f32 v116, v116
    v_exp_f32 v117, v117
    v_smfmac_f32_32x32x32_bf16 v[76:91], v[28:31], v[108:115], v43
    v_exp_f32 v118, v118
    v_exp_f32 v119, v119
    v_exp_f32 v120, v120
    v_exp_f32 v121, v121
    v_exp_f32 v122, v122
    v_exp_f32 v123, v123
    v_sub_f32 v92, v92, v44
    v_sub_f32 v93, v93, v44
    v_sub_f32 v94, v94, v44
    v_sub_f32 v95, v95, v44
    v_sub_f32 v96, v96, v44
    v_sub_f32 v97, v97, v44
    v_sub_f32 v98, v98, v44
    v_sub_f32 v99, v99, v44
    v_sub_f32 v100, v100, v44
    v_sub_f32 v101, v101, v44
    v_sub_f32 v102, v102, v44
    v_sub_f32 v103, v103, v44
    v_sub_f32 v104, v104, v44
    v_sub_f32 v105, v105, v44
    v_sub_f32 v106, v106, v44
    v_sub_f32 v107, v107, v44
    v_exp_f32 v92, v92
    v_exp_f32 v93, v93
    v_smfmac_f32_32x32x32_bf16 v[76:91], v[32:35], v[116:123], v43
    s_mov_b64 exec, s[60:61]
    ds_read_b128 v[28:31], v2 offset:52224
    ds_read_b128 v[32:35], v2 offset:51968
    s_mov_b64 exec, -1
    s_add_u32 s13, s62, 1
    s_and_b32 s14, s13, 7
    s_lshr_b32 s13, s13, 3
    s_lshl_b32 s13, s13, 14
    s_lshl_b32 s14, s14, 7
    s_add_u32 s13, s13, s14
    buffer_load_dword v127, v126, s[56:59], s13 offen
    s_add_u32 s13, s62, 2
    s_and_b32 s14, s13, 7
    s_lshr_b32 s13, s13, 3
    s_lshl_b32 s13, s13, 14
    s_lshl_b32 s14, s14, 7
    s_add_u32 s13, s13, s14
    buffer_load_dword v127, v126, s[56:59], s13 offen
    v_exp_f32 v94, v94
    v_exp_f32 v95, v95
    v_exp_f32 v96, v96
    v_mfma_f32_32x32x16_bf16 v[108:123], v[12:15], v[8:11], 0
    ds_read_b128 v[16:19], v2 offset:51200
    s_waitcnt vmcnt(10)
    ds_read_b64_tr_b16 v[240:241], v124 offset:0
    ds_read_b64_tr_b16 v[242:243], v124 offset:256
    ds_read_b64_tr_b16 v[244:245], v124 offset:1024
    ds_read_b64_tr_b16 v[246:247], v124 offset:1280
    v_exp_f32 v97, v97
    v_exp_f32 v98, v98
    v_exp_f32 v99, v99
    v_exp_f32 v100, v100
    v_exp_f32 v101, v101
    v_smfmac_f32_32x32x32_bf16 v[60:75], v[20:23], v[92:99], v43
    v_exp_f32 v102, v102
    v_exp_f32 v103, v103
    v_exp_f32 v104, v104
    v_exp_f32 v105, v105
    v_exp_f32 v106, v106
    v_exp_f32 v107, v107
    v_sub_f32 v108, v108, v45
    v_sub_f32 v109, v109, v45
    v_sub_f32 v110, v110, v45
    v_sub_f32 v111, v111, v45
    v_sub_f32 v112, v112, v45
    v_sub_f32 v113, v113, v45
    v_sub_f32 v114, v114, v45
    v_sub_f32 v115, v115, v45
    v_sub_f32 v116, v116, v45
    v_sub_f32 v117, v117, v45
    v_sub_f32 v118, v118, v45
    v_sub_f32 v119, v119, v45
    v_sub_f32 v120, v120, v45
    v_sub_f32 v121, v121, v45
    v_sub_f32 v122, v122, v45
    v_sub_f32 v123, v123, v45
    v_exp_f32 v108, v108
    v_exp_f32 v109, v109
    v_smfmac_f32_32x32x32_bf16 v[60:75], v[24:27], v[100:107], v43
    v_exp_f32 v110, v110
    v_exp_f32 v111, v111
    v_exp_f32 v112, v112
    s_waitcnt lgkmcnt(0)
    v_mfma_f32_32x32x16_bf16 v[92:107], v[16:19], v[4:7], 0
    v_exp_f32 v113, v113
    v_exp_f32 v114, v114
    v_exp_f32 v115, v115
    v_exp_f32 v116, v116
    v_exp_f32 v117, v117
    v_smfmac_f32_32x32x32_bf16 v[76:91], v[20:23], v[108:115], v43
    v_exp_f32 v118, v118
    v_exp_f32 v119, v119
    v_exp_f32 v120, v120
    v_exp_f32 v121, v121
    v_exp_f32 v122, v122
    v_exp_f32 v123, v123
    v_sub_f32 v92, v92, v44
    v_sub_f32 v93, v93, v44
    v_sub_f32 v94, v94, v44
    v_sub_f32 v95, v95, v44
    v_sub_f32 v96, v96, v44
    v_sub_f32 v97, v97, v44
    v_sub_f32 v98, v98, v44
    v_sub_f32 v99, v99, v44
    v_sub_f32 v100, v100, v44
    v_sub_f32 v101, v101, v44
    v_sub_f32 v102, v102, v44
    v_sub_f32 v103, v103, v44
    v_sub_f32 v104, v104, v44
    v_sub_f32 v105, v105, v44
    v_sub_f32 v106, v106, v44
    v_sub_f32 v107, v107, v44
    v_exp_f32 v92, v92
    v_exp_f32 v93, v93
    v_smfmac_f32_32x32x32_bf16 v[76:91], v[24:27], v[116:123], v43
    s_mov_b64 exec, s[60:61]
    ds_read_b128 v[20:23], v2 offset:54272
    ds_read_b128 v[24:27], v2 offset:54016
    s_mov_b64 exec, -1
    v_exp_f32 v94, v94
    v_exp_f32 v95, v95
    v_exp_f32 v96, v96
    v_mfma_f32_32x32x16_bf16 v[108:123], v[16:19], v[8:11], 0
    ds_read_b128 v[12:15], v2 offset:53248
    s_waitcnt vmcnt(8)
    ds_read_b64_tr_b16 v[248:249], v41 offset:0
    ds_read_b64_tr_b16 v[250:251], v41 offset:256
    ds_read_b64_tr_b16 v[252:253], v41 offset:16384
    ds_read_b64_tr_b16 v[254:255], v41 offset:16640
    v_exp_f32 v97, v97
    v_exp_f32 v98, v98
    v_exp_f32 v99, v99
    v_exp_f32 v100, v100
    v_exp_f32 v101, v101
    v_smfmac_f32_32x32x32_bf16 v[60:75], v[28:31], v[92:99], v43
    v_exp_f32 v102, v102
    v_exp_f32 v103, v103
    v_exp_f32 v104, v104
    v_exp_f32 v105, v105
    v_exp_f32 v106, v106
    v_exp_f32 v107, v107
    v_sub_f32 v108, v108, v45
    v_sub_f32 v109, v109, v45
    v_sub_f32 v110, v110, v45
    v_sub_f32 v111, v111, v45
    v_sub_f32 v112, v112, v45
    v_sub_f32 v113, v113, v45
    v_sub_f32 v114, v114, v45
    v_sub_f32 v115, v115, v45
    v_sub_f32 v116, v116, v45
    v_sub_f32 v117, v117, v45
    v_sub_f32 v118, v118, v45
    v_sub_f32 v119, v119, v45
    v_sub_f32 v120, v120, v45
    v_sub_f32 v121, v121, v45
    v_sub_f32 v122, v122, v45
    v_sub_f32 v123, v123, v45
    v_exp_f32 v108, v108
    v_exp_f32 v109, v109
    v_smfmac_f32_32x32x32_bf16 v[60:75], v[32:35], v[100:107], v43
    v_exp_f32 v110, v110
    v_exp_f32 v111, v111
    v_exp_f32 v112, v112
    s_waitcnt lgkmcnt(0)
    v_mfma_f32_32x32x16_bf16 v[92:107], v[12:15], v[4:7], 0
    s_add_u32 m0, s10, 0
    s_add_u32 s13, s69, 0
    buffer_load_dwordx4 v126, s[48:51], s13 offen lds
    s_add_u32 m0, s10, 16384
    s_add_u32 s13, s69, 64
    buffer_load_dwordx4 v126, s[48:51], s13 offen lds
    v_exp_f32 v113, v113
    v_exp_f32 v114, v114
    v_exp_f32 v115, v115
    v_exp_f32 v116, v116
    v_exp_f32 v117, v117
    v_smfmac_f32_32x32x32_bf16 v[76:91], v[28:31], v[108:115], v43
    v_exp_f32 v118, v118
    v_exp_f32 v119, v119
    v_exp_f32 v120, v120
    v_exp_f32 v121, v121
    v_exp_f32 v122, v122
    v_exp_f32 v123, v123
    v_sub_f32 v92, v92, v44
    v_sub_f32 v93, v93, v44
    v_sub_f32 v94, v94, v44
    v_sub_f32 v95, v95, v44
    v_sub_f32 v96, v96, v44
    v_sub_f32 v97, v97, v44
    v_sub_f32 v98, v98, v44
    v_sub_f32 v99, v99, v44
    v_sub_f32 v100, v100, v44
    v_sub_f32 v101, v101, v44
    v_sub_f32 v102, v102, v44
    v_sub_f32 v103, v103, v44
    v_sub_f32 v104, v104, v44
    v_sub_f32 v105, v105, v44
    v_sub_f32 v106, v106, v44
    v_sub_f32 v107, v107, v44
    v_exp_f32 v92, v92
    v_exp_f32 v93, v93
    v_smfmac_f32_32x32x32_bf16 v[76:91], v[32:35], v[116:123], v43
    s_mov_b64 exec, s[60:61]
    ds_read_b128 v[28:31], v2 offset:56320
    ds_read_b128 v[32:35], v2 offset:56064
    s_mov_b64 exec, -1
    buffer_load_dword v127, v3, s[52:55], s64 offen offset:0 sc1
    buffer_load_dword v127, v3, s[52:55], s64 offen offset:1024 sc1
    v_exp_f32 v94, v94
    v_exp_f32 v95, v95
    v_exp_f32 v96, v96
    v_mfma_f32_32x32x16_bf16 v[108:123], v[12:15], v[8:11], 0
    ds_read_b128 v[16:19], v2 offset:55296
    v_exp_f32 v97, v97
    v_exp_f32 v98, v98
    v_exp_f32 v99, v99
    v_exp_f32 v100, v100
    v_exp_f32 v101, v101
    v_smfmac_f32_32x32x32_bf16 v[60:75], v[20:23], v[92:99], v43
    v_exp_f32 v102, v102
    v_exp_f32 v103, v103
    v_exp_f32 v104, v104
    v_exp_f32 v105, v105
    v_exp_f32 v106, v106
    v_exp_f32 v107, v107
    v_sub_f32 v108, v108, v45
    v_sub_f32 v109, v109, v45
    v_sub_f32 v110, v110, v45
    v_sub_f32 v111, v111, v45
    v_sub_f32 v112, v112, v45
    v_sub_f32 v113, v113, v45
    v_sub_f32 v114, v114, v45
    v_sub_f32 v115, v115, v45
    v_sub_f32 v116, v116, v45
    v_sub_f32 v117, v117, v45
    v_sub_f32 v118, v118, v45
    v_sub_f32 v119, v119, v45
    v_sub_f32 v120, v120, v45
    v_sub_f32 v121, v121, v45
    v_sub_f32 v122, v122, v45
    v_sub_f32 v123, v123, v45
    v_exp_f32 v108, v108
    v_exp_f32 v109, v109
    v_smfmac_f32_32x32x32_bf16 v[60:75], v[24:27], v[100:107], v43
    v_exp_f32 v110, v110
    v_exp_f32 v111, v111
    v_exp_f32 v112, v112
    s_waitcnt lgkmcnt(0)
    v_mfma_f32_32x32x16_bf16 v[92:107], v[16:19], v[4:7], 0
    v_exp_f32 v113, v113
    v_exp_f32 v114, v114
    v_exp_f32 v115, v115
    v_exp_f32 v116, v116
    v_exp_f32 v117, v117
    v_smfmac_f32_32x32x32_bf16 v[76:91], v[20:23], v[108:115], v43
    v_exp_f32 v118, v118
    v_exp_f32 v119, v119
    v_exp_f32 v120, v120
    v_exp_f32 v121, v121
    v_exp_f32 v122, v122
    v_exp_f32 v123, v123
    v_sub_f32 v92, v92, v44
    v_sub_f32 v93, v93, v44
    v_sub_f32 v94, v94, v44
    v_sub_f32 v95, v95, v44
    v_sub_f32 v96, v96, v44
    v_sub_f32 v97, v97, v44
    v_sub_f32 v98, v98, v44
    v_sub_f32 v99, v99, v44
    v_sub_f32 v100, v100, v44
    v_sub_f32 v101, v101, v44
    v_sub_f32 v102, v102, v44
    v_sub_f32 v103, v103, v44
    v_sub_f32 v104, v104, v44
    v_sub_f32 v105, v105, v44
    v_sub_f32 v106, v106, v44
    v_sub_f32 v107, v107, v44
    v_exp_f32 v92, v92
    v_exp_f32 v93, v93
    v_smfmac_f32_32x32x32_bf16 v[76:91], v[24:27], v[116:123], v43
    s_mov_b64 exec, s[60:61]
    ds_read_b128 v[20:23], v2 offset:58368
    ds_read_b128 v[24:27], v2 offset:58112
    s_mov_b64 exec, -1
    buffer_load_dword v127, v3, s[52:55], s95 offen offset:0 sc1
    buffer_load_dword v127, v3, s[84:87], s67 offen
    v_exp_f32 v94, v94
    v_exp_f32 v95, v95
    v_exp_f32 v96, v96
    v_mfma_f32_32x32x16_bf16 v[108:123], v[16:19], v[8:11], 0
    ds_read_b128 v[12:15], v2 offset:57344
    v_exp_f32 v97, v97
    v_exp_f32 v98, v98
    v_exp_f32 v99, v99
    v_exp_f32 v100, v100
    v_exp_f32 v101, v101
    v_smfmac_f32_32x32x32_bf16 v[60:75], v[28:31], v[92:99], v43
    v_exp_f32 v102, v102
    v_exp_f32 v103, v103
    v_exp_f32 v104, v104
    v_exp_f32 v105, v105
    v_exp_f32 v106, v106
    v_exp_f32 v107, v107
    v_sub_f32 v108, v108, v45
    v_sub_f32 v109, v109, v45
    v_sub_f32 v110, v110, v45
    v_sub_f32 v111, v111, v45
    v_sub_f32 v112, v112, v45
    v_sub_f32 v113, v113, v45
    v_sub_f32 v114, v114, v45
    v_sub_f32 v115, v115, v45
    v_sub_f32 v116, v116, v45
    v_sub_f32 v117, v117, v45
    v_sub_f32 v118, v118, v45
    v_sub_f32 v119, v119, v45
    v_sub_f32 v120, v120, v45
    v_sub_f32 v121, v121, v45
    v_sub_f32 v122, v122, v45
    v_sub_f32 v123, v123, v45
    v_exp_f32 v108, v108
    v_exp_f32 v109, v109
    v_smfmac_f32_32x32x32_bf16 v[60:75], v[32:35], v[100:107], v43
    v_exp_f32 v110, v110
    v_exp_f32 v111, v111
    v_exp_f32 v112, v112
    s_waitcnt lgkmcnt(0)
    v_mfma_f32_32x32x16_bf16 v[92:107], v[12:15], v[4:7], 0
    v_exp_f32 v113, v113
    v_exp_f32 v114, v114
    v_exp_f32 v115, v115
    v_exp_f32 v116, v116
    v_exp_f32 v117, v117
    v_smfmac_f32_32x32x32_bf16 v[76:91], v[28:31], v[108:115], v43
    v_exp_f32 v118, v118
    v_exp_f32 v119, v119
    v_exp_f32 v120, v120
    v_exp_f32 v121, v121
    v_exp_f32 v122, v122
    v_exp_f32 v123, v123
    v_sub_f32 v92, v92, v44
    v_sub_f32 v93, v93, v44
    v_sub_f32 v94, v94, v44
    v_sub_f32 v95, v95, v44
    v_sub_f32 v96, v96, v44
    v_sub_f32 v97, v97, v44
    v_sub_f32 v98, v98, v44
    v_sub_f32 v99, v99, v44
    v_sub_f32 v100, v100, v44
    v_sub_f32 v101, v101, v44
    v_sub_f32 v102, v102, v44
    v_sub_f32 v103, v103, v44
    v_sub_f32 v104, v104, v44
    v_sub_f32 v105, v105, v44
    v_sub_f32 v106, v106, v44
    v_sub_f32 v107, v107, v44
    v_exp_f32 v92, v92
    v_exp_f32 v93, v93
    v_smfmac_f32_32x32x32_bf16 v[76:91], v[32:35], v[116:123], v43
    s_mov_b64 exec, s[60:61]
    ds_read_b128 v[28:31], v2 offset:60416
    ds_read_b128 v[32:35], v2 offset:60160
    s_mov_b64 exec, -1
    buffer_load_dword v127, v3, s[88:91], 0 offen
    s_getpc_b64 s[14:15]
L_cqs:
    s_sub_u32 s14, s14, L_cqs-L_k2_done
    s_subb_u32 s15, s15, 0
    s_and_b32 s13, s5, 1
    s_lshl_b32 s13, s13, 13
    s_add_u32 s13, s13, s10
    s_add_u32 s14, s14, s13
    s_addc_u32 s15, s15, 0
    global_load_dword v127, v3, s[14:15]
    v_exp_f32 v94, v94
    v_exp_f32 v95, v95
    v_exp_f32 v96, v96
    v_mfma_f32_32x32x16_bf16 v[108:123], v[12:15], v[8:11], 0
    ds_read_b128 v[16:19], v2 offset:59392
    v_exp_f32 v97, v97
    v_exp_f32 v98, v98
    v_exp_f32 v99, v99
    v_exp_f32 v100, v100
    v_exp_f32 v101, v101
    v_smfmac_f32_32x32x32_bf16 v[60:75], v[20:23], v[92:99], v43
    v_exp_f32 v102, v102
    v_exp_f32 v103, v103
    v_exp_f32 v104, v104
    v_exp_f32 v105, v105
    v_exp_f32 v106, v106
    v_exp_f32 v107, v107
    v_sub_f32 v108, v108, v45
    v_sub_f32 v109, v109, v45
    v_sub_f32 v110, v110, v45
    v_sub_f32 v111, v111, v45
    v_sub_f32 v112, v112, v45
    v_sub_f32 v113, v113, v45
    v_sub_f32 v114, v114, v45
    v_sub_f32 v115, v115, v45
    v_sub_f32 v116, v116, v45
    v_sub_f32 v117, v117, v45
    v_sub_f32 v118, v118, v45
    v_sub_f32 v119, v119, v45
    v_sub_f32 v120, v120, v45
    v_sub_f32 v121, v121, v45
    v_sub_f32 v122, v122, v45
    v_sub_f32 v123, v123, v45
    v_exp_f32 v108, v108
    v_exp_f32 v109, v109
    v_smfmac_f32_32x32x32_bf16 v[60:75], v[24:27], v[100:107], v43
    v_exp_f32 v110, v110
    v_exp_f32 v111, v111
    v_exp_f32 v112, v112
    s_waitcnt lgkmcnt(0)
    v_mfma_f32_32x32x16_bf16 v[92:107], v[16:19], v[4:7], 0
    v_exp_f32 v113, v113
    v_exp_f32 v114, v114
    v_exp_f32 v115, v115
    v_exp_f32 v116, v116
    v_exp_f32 v117, v117
    v_smfmac_f32_32x32x32_bf16 v[76:91], v[20:23], v[108:115], v43
    v_exp_f32 v118, v118
    v_exp_f32 v119, v119
    v_exp_f32 v120, v120
    v_exp_f32 v121, v121
    v_exp_f32 v122, v122
    v_exp_f32 v123, v123
    v_sub_f32 v92, v92, v44
    v_sub_f32 v93, v93, v44
    v_sub_f32 v94, v94, v44
    v_sub_f32 v95, v95, v44
    v_sub_f32 v96, v96, v44
    v_sub_f32 v97, v97, v44
    v_sub_f32 v98, v98, v44
    v_sub_f32 v99, v99, v44
    v_sub_f32 v100, v100, v44
    v_sub_f32 v101, v101, v44
    v_sub_f32 v102, v102, v44
    v_sub_f32 v103, v103, v44
    v_sub_f32 v104, v104, v44
    v_sub_f32 v105, v105, v44
    v_sub_f32 v106, v106, v44
    v_sub_f32 v107, v107, v44
    v_exp_f32 v92, v92
    v_exp_f32 v93, v93
    v_smfmac_f32_32x32x32_bf16 v[76:91], v[24:27], v[116:123], v43
    s_mov_b64 exec, s[60:61]
    ds_read_b128 v[20:23], v2 offset:62464
    ds_read_b128 v[24:27], v2 offset:62208
    s_mov_b64 exec, -1
    v_exp_f32 v94, v94
    v_exp_f32 v95, v95
    v_exp_f32 v96, v96
    v_mfma_f32_32x32x16_bf16 v[108:123], v[16:19], v[8:11], 0
    ds_read_b128 v[12:15], v2 offset:61440
    v_exp_f32 v97, v97
    v_exp_f32 v98, v98
    v_exp_f32 v99, v99
    v_exp_f32 v100, v100
    v_exp_f32 v101, v101
    v_smfmac_f32_32x32x32_bf16 v[60:75], v[28:31], v[92:99], v43
    v_exp_f32 v102, v102
    v_exp_f32 v103, v103
    v_exp_f32 v104, v104
    v_exp_f32 v105, v105
    v_exp_f32 v106, v106
    v_exp_f32 v107, v107
    s_setprio 1
    v_sub_f32 v108, v108, v45
    v_sub_f32 v109, v109, v45
    v_sub_f32 v110, v110, v45
    v_sub_f32 v111, v111, v45
    v_sub_f32 v112, v112, v45
    v_sub_f32 v113, v113, v45
    v_sub_f32 v114, v114, v45
    v_sub_f32 v115, v115, v45
    v_sub_f32 v116, v116, v45
    v_sub_f32 v117, v117, v45
    v_sub_f32 v118, v118, v45
    v_sub_f32 v119, v119, v45
    v_sub_f32 v120, v120, v45
    v_sub_f32 v121, v121, v45
    v_sub_f32 v122, v122, v45
    v_sub_f32 v123, v123, v45
    v_exp_f32 v108, v108
    v_exp_f32 v109, v109
    v_smfmac_f32_32x32x32_bf16 v[60:75], v[32:35], v[100:107], v43
    v_exp_f32 v110, v110
    v_exp_f32 v111, v111
    v_exp_f32 v112, v112
    s_waitcnt lgkmcnt(0)
    v_mfma_f32_32x32x16_bf16 v[92:107], v[12:15], v[4:7], 0
    buffer_load_dword v127, v3, s[52:55], s68 offen sc1
    v_exp_f32 v113, v113
    v_exp_f32 v114, v114
    v_exp_f32 v115, v115
    v_exp_f32 v116, v116
    v_exp_f32 v117, v117
    v_smfmac_f32_32x32x32_bf16 v[76:91], v[28:31], v[108:115], v43
    v_exp_f32 v118, v118
    v_exp_f32 v119, v119
    v_exp_f32 v120, v120
    v_exp_f32 v121, v121
    v_exp_f32 v122, v122
    v_exp_f32 v123, v123
    v_sub_f32 v92, v92, v44
    v_sub_f32 v93, v93, v44
    v_sub_f32 v94, v94, v44
    v_sub_f32 v95, v95, v44
    v_sub_f32 v96, v96, v44
    v_sub_f32 v97, v97, v44
    v_sub_f32 v98, v98, v44
    v_sub_f32 v99, v99, v44
    v_sub_f32 v100, v100, v44
    v_sub_f32 v101, v101, v44
    v_sub_f32 v102, v102, v44
    v_sub_f32 v103, v103, v44
    v_sub_f32 v104, v104, v44
    v_sub_f32 v105, v105, v44
    v_sub_f32 v106, v106, v44
    v_sub_f32 v107, v107, v44
    v_exp_f32 v92, v92
    v_exp_f32 v93, v93
    v_smfmac_f32_32x32x32_bf16 v[76:91], v[32:35], v[116:123], v43
    s_mov_b64 exec, s[60:61]
    ds_read_b128 v[28:31], v2 offset:64512
    ds_read_b128 v[32:35], v2 offset:64256
    s_mov_b64 exec, -1
    v_exp_f32 v94, v94
    v_exp_f32 v95, v95
    v_exp_f32 v96, v96
    v_mfma_f32_32x32x16_bf16 v[108:123], v[12:15], v[8:11], 0
    ds_read_b128 v[16:19], v2 offset:63488
    v_exp_f32 v97, v97
    v_exp_f32 v98, v98
    v_exp_f32 v99, v99
    v_exp_f32 v100, v100
    v_exp_f32 v101, v101
    v_smfmac_f32_32x32x32_bf16 v[60:75], v[20:23], v[92:99], v43
    v_exp_f32 v102, v102
    v_exp_f32 v103, v103
    v_exp_f32 v104, v104
    v_exp_f32 v105, v105
    v_exp_f32 v106, v106
    v_exp_f32 v107, v107
    v_sub_f32 v108, v108, v45
    v_sub_f32 v109, v109, v45
    v_sub_f32 v110, v110, v45
    v_sub_f32 v111, v111, v45
    v_sub_f32 v112, v112, v45
    v_sub_f32 v113, v113, v45
    v_sub_f32 v114, v114, v45
    v_sub_f32 v115, v115, v45
    v_sub_f32 v116, v116, v45
    v_sub_f32 v117, v117, v45
    v_sub_f32 v118, v118, v45
    v_sub_f32 v119, v119, v45
    v_sub_f32 v120, v120, v45
    v_sub_f32 v121, v121, v45
    v_sub_f32 v122, v122, v45
    v_sub_f32 v123, v123, v45
    v_exp_f32 v108, v108
    v_exp_f32 v109, v109
    v_smfmac_f32_32x32x32_bf16 v[60:75], v[24:27], v[100:107], v43
    v_exp_f32 v110, v110
    v_exp_f32 v111, v111
    v_exp_f32 v112, v112
    s_waitcnt lgkmcnt(0)
    v_mfma_f32_32x32x16_bf16 v[92:107], v[16:19], v[4:7], 0
    v_exp_f32 v113, v113
    v_exp_f32 v114, v114
    v_exp_f32 v115, v115
    v_exp_f32 v116, v116
    v_exp_f32 v117, v117
    v_smfmac_f32_32x32x32_bf16 v[76:91], v[20:23], v[108:115], v43
    v_exp_f32 v118, v118
    v_exp_f32 v119, v119
    v_exp_f32 v120, v120
    v_exp_f32 v121, v121
    v_exp_f32 v122, v122
    v_exp_f32 v123, v123
    v_sub_f32 v92, v92, v44
    v_sub_f32 v93, v93, v44
    v_sub_f32 v94, v94, v44
    v_sub_f32 v95, v95, v44
    v_sub_f32 v96, v96, v44
    v_sub_f32 v97, v97, v44
    v_sub_f32 v98, v98, v44
    v_sub_f32 v99, v99, v44
    v_sub_f32 v100, v100, v44
    v_sub_f32 v101, v101, v44
    v_sub_f32 v102, v102, v44
    v_sub_f32 v103, v103, v44
    v_sub_f32 v104, v104, v44
    v_sub_f32 v105, v105, v44
    v_sub_f32 v106, v106, v44
    v_sub_f32 v107, v107, v44
    v_exp_f32 v92, v92
    v_exp_f32 v93, v93
    v_smfmac_f32_32x32x32_bf16 v[76:91], v[24:27], v[116:123], v43
    v_exp_f32 v94, v94
    v_exp_f32 v95, v95
    v_exp_f32 v96, v96
    v_mfma_f32_32x32x16_bf16 v[108:123], v[16:19], v[8:11], 0
    v_exp_f32 v97, v97
    v_exp_f32 v98, v98
    v_exp_f32 v99, v99
    v_exp_f32 v100, v100
    v_exp_f32 v101, v101
    v_smfmac_f32_32x32x32_bf16 v[60:75], v[28:31], v[92:99], v43
    v_exp_f32 v102, v102
    v_exp_f32 v103, v103
    v_exp_f32 v104, v104
    v_exp_f32 v105, v105
    v_exp_f32 v106, v106
    v_exp_f32 v107, v107
    s_setprio 0
    v_sub_f32 v108, v108, v45
    v_sub_f32 v109, v109, v45
    v_sub_f32 v110, v110, v45
    v_sub_f32 v111, v111, v45
    v_sub_f32 v112, v112, v45
    v_sub_f32 v113, v113, v45
    v_sub_f32 v114, v114, v45
    v_sub_f32 v115, v115, v45
    v_sub_f32 v116, v116, v45
    v_sub_f32 v117, v117, v45
    v_sub_f32 v118, v118, v45
    v_sub_f32 v119, v119, v45
    v_sub_f32 v120, v120, v45
    v_sub_f32 v121, v121, v45
    v_sub_f32 v122, v122, v45
    v_sub_f32 v123, v123, v45
    v_exp_f32 v108, v108
    v_exp_f32 v109, v109
    v_smfmac_f32_32x32x32_bf16 v[60:75], v[32:35], v[100:107], v43
    v_exp_f32 v110, v110
    v_exp_f32 v111, v111
    v_exp_f32 v112, v112
    s_waitcnt lgkmcnt(0)
    s_waitcnt vmcnt(0)
    v_cmp_ne_u32 vcc, s42, v127
    s_or_b32 s42, vcc_lo, vcc_hi
    s_and_b32 s42, s42, 0x01010101
    v_exp_f32 v113, v113
    v_exp_f32 v114, v114
    v_exp_f32 v115, v115
    v_exp_f32 v116, v116
    v_exp_f32 v117, v117
    v_smfmac_f32_32x32x32_bf16 v[76:91], v[28:31], v[108:115], v43
    v_exp_f32 v118, v118
    v_exp_f32 v119, v119
    v_exp_f32 v120, v120
    v_exp_f32 v121, v121
    v_exp_f32 v122, v122
    v_exp_f32 v123, v123
    s_nop 3
    s_branch L_k2_done
.section .rodata,"a"
.p2align 6
.amdhsa_kernel sequential_preLN__grouped_kv_mqa__dense_activation_gelu__prompt_kernel
  .amdhsa_next_free_vgpr 256
  .amdhsa_next_free_sgpr 102
  .amdhsa_accum_offset 256
  .amdhsa_group_segment_fixed_size 0
  .amdhsa_kernarg_size 104
  .amdhsa_user_sgpr_count 2
  .amdhsa_user_sgpr_kernarg_segment_ptr 1
  .amdhsa_system_sgpr_workgroup_id_x 1
.end_amdhsa_kernel
```
